```python
import torch

def _softmax(x, axis=-1):
    return torch.softmax(x, dim=axis)
def _gelu(x):
    return torch.nn.functional.gelu(x, approximate="tanh")
def _silu(x):
    return torch.nn.functional.silu(x)
def _sigmoid(x):
    return torch.sigmoid(x)
def _layernorm(x, axis=-1, eps=1e-5):
    m = x.mean(dim=axis, keepdim=True)
    v = x.var(dim=axis, keepdim=True, unbiased=False)
    return (x - m) / torch.sqrt(v + eps)
def _scatter_add(tgt, idx, src, axis=0):
    return tgt.clone().index_add_(axis, idx, src)
def _segment_sum(src, seg, n):
    out = torch.zeros((n,) + src.shape[1:], dtype=src.dtype)
    return out.index_add_(0, seg, src)
def _pad(x, pw):
    flat = tuple(v for pair in reversed(pw) for v in pair)
    return torch.nn.functional.pad(x, flat)

kernel_name = 'interleave_layers__grouped_kv_mqa__mixer_channel_mlp__prompt'

def setup_inputs():

    _w = (lambda a: (lambda t: t.to(torch.bfloat16) if t.is_floating_point() else t)(torch.as_tensor(a)))
    def _A_setup():
        B, S, D, H = 1, 2048, 640, 32
        Dh = D // H
        return {
            "x": _w((lambda *s: torch.randn(*s, dtype=torch.bfloat16) * 0.05)(B, S, D)),
            "wq": _w((lambda *s: torch.randn(*s, dtype=torch.bfloat16) * 0.05)(D, H * Dh)),
            "wk": _w((lambda *s: torch.randn(*s, dtype=torch.bfloat16) * 0.05)(D, Dh)),
            "wv": _w((lambda *s: torch.randn(*s, dtype=torch.bfloat16) * 0.05)(D, Dh)),
            "wo": _w((lambda *s: torch.randn(*s, dtype=torch.bfloat16) * 0.05)(H * Dh, D)),
        }
    _A_in = _A_setup()

    def _B_setup():
        B, S, D, F = 1, 2048, 640, 1728
        return {
            "x": _w((lambda *s: torch.randn(*s, dtype=torch.bfloat16) * 0.05)(B, S, D)),
            "w1": _w((lambda *s: torch.randn(*s, dtype=torch.bfloat16) * 3.2)(D, F) * (D ** -0.5)),
            "b1": _w((lambda *s: torch.randn(*s, dtype=torch.bfloat16) * 0.8)(F)),
            "w2": _w((lambda *s: torch.randn(*s, dtype=torch.bfloat16) * 0.4)(F, D) * (F ** -0.5)),
            "b2": _w((lambda *s: torch.randn(*s, dtype=torch.bfloat16) * 0.4)(D)),
        }
    _B_in = _B_setup()

    return {
        "A_x": _A_in["x"],
        "A_wq": _A_in["wq"],
        "A_wk": _A_in["wk"],
        "A_wv": _A_in["wv"],
        "A_wo": _A_in["wo"],
        "B_x": _B_in["x"],
        "B_w1": _B_in["w1"],
        "B_b1": _B_in["b1"],
        "B_w2": _B_in["w2"],
        "B_b2": _B_in["b2"],
    }

def reference(A_x, A_wq, A_wk, A_wv, A_wo, B_x, B_w1, B_b1, B_w2, B_b2):
    def _A_ref(x, wq, wk, wv, wo):
        B, S, D = x.shape
        H = 32
        Dh = D // H
        q = (lambda x, *d: x.permute(*d))((x @ wq).reshape(B, S, H, Dh), 0, 2, 1, 3)
        k = x @ wk
        v = x @ wv
        scores = torch.einsum("bhqd,bkd->bhqk", q, k) * (Dh ** -0.5)
        p = _softmax(scores, axis=-1)
        o = torch.einsum("bhqk,bkd->bhqd", p, v)
        return (lambda x, *d: x.permute(*d))(o, 0, 2, 1, 3).reshape(B, S, H * Dh) @ wo

    def _B_ref(x, w1, b1, w2, b2):
        y = _layernorm(x, axis=-1)
        h = _gelu(torch.einsum("bsd,df->bsf", y, w1) + b1)
        return torch.einsum("bsf,fd->bsd", h, w2) + b2

    x = A_x
    x = x + _A_ref(_layernorm(x, axis=-1), A_wq, A_wk, A_wv, A_wo)
    x = x + _B_ref(_layernorm(x, axis=-1), B_w1, B_b1, B_w2, B_b2)
    x = x + _A_ref(_layernorm(x, axis=-1), A_wq, A_wk, A_wv, A_wo)
    x = x + _B_ref(_layernorm(x, axis=-1), B_w1, B_b1, B_w2, B_b2)
    return x
```

```asm
; @launch grid=(256,1,1) block=(512,1,1) lds=163840
.amdgcn_target "amdgcn-amd-amdhsa--gfx950"
.text
.globl interleave_layers__grouped_kv_mqa__mixer_channel_mlp__prompt_kernel
.p2align 8
.type interleave_layers__grouped_kv_mqa__mixer_channel_mlp__prompt_kernel,@function
interleave_layers__grouped_kv_mqa__mixer_channel_mlp__prompt_kernel:
    s_cmp_ge_u32 s2, 256
    s_cbranch_scc1 mega_kernel_exit
    s_load_dwordx16 s[64:79], s[0:1], 0
    s_load_dwordx4 s[80:83], s[0:1], 64
    s_load_dwordx2 s[84:85], s[0:1], 80
    s_load_dwordx2 s[86:87], s[0:1], 96
    s_load_dwordx2 s[58:59], s[0:1], 88
    v_lshrrev_b32 v24, 6, v0
    v_and_b32 v1, 63, v0
    v_readfirstlane_b32 s3, v24
    s_and_b32 s4, s3, 3
    s_lshr_b32 s5, s3, 2
    s_and_b32 s6, s2, 7
    s_lshl_b32 s6, s6, 2
    s_lshr_b32 s7, s2, 3
    s_and_b32 s7, s7, 3
    s_add_u32 s6, s6, s7
    s_lshr_b32 s7, s2, 5
    v_and_b32 v2, 15, v1
    v_lshrrev_b32 v3, 4, v1
    v_lshlrev_b32 v4, 4, v1
    v_and_b32 v5, 31, v1
    v_lshrrev_b32 v6, 5, v1
    v_lshrrev_b32 v24, 2, v2
    v_and_b32 v25, 1, v3
    v_lshl_add_u32 v24, v25, 2, v24
    v_lshrrev_b32 v25, 1, v3
    v_lshl_add_u32 v24, v25, 4, v24
    v_mul_u32_u24 v24, 160, v24
    v_and_b32 v25, 3, v1
    v_lshl_add_u32 v7, v25, 3, v24
    s_lshl_b32 s28, s6, 6
    s_lshl_b32 s29, s4, 4
    s_add_u32 s28, s28, s29
    v_add_u32 v14, s28, v2
    s_mul_i32 s29, s7, 160
    v_add_u32 v24, 0, v1
    v_mul_u32_u24 v25, 6554, v24
    v_lshrrev_b32 v25, 16, v25
    v_mul_u32_u24 v26, 10, v25
    v_sub_u32 v26, v24, v26
    v_and_b32 v27, 0x13, v25
    v_bfe_u32 v28, v25, 3, 1
    v_lshl_add_u32 v27, v28, 2, v27
    v_bfe_u32 v28, v25, 2, 1
    v_lshl_add_u32 v27, v28, 3, v27
    v_mul_u32_u24 v27, 1280, v27
    v_lshl_add_u32 v27, v26, 4, v27
    v_add_u32 v16, s29, v27
    v_add_u32 v24, 64, v1
    v_mul_u32_u24 v25, 6554, v24
    v_lshrrev_b32 v25, 16, v25
    v_mul_u32_u24 v26, 10, v25
    v_sub_u32 v26, v24, v26
    v_and_b32 v27, 0x13, v25
    v_bfe_u32 v28, v25, 3, 1
    v_lshl_add_u32 v27, v28, 2, v27
    v_bfe_u32 v28, v25, 2, 1
    v_lshl_add_u32 v27, v28, 3, v27
    v_mul_u32_u24 v27, 1280, v27
    v_lshl_add_u32 v27, v26, 4, v27
    v_add_u32 v17, s29, v27
    v_add_u32 v24, 128, v1
    v_mul_u32_u24 v25, 6554, v24
    v_lshrrev_b32 v25, 16, v25
    v_mul_u32_u24 v26, 10, v25
    v_sub_u32 v26, v24, v26
    v_and_b32 v27, 0x13, v25
    v_bfe_u32 v28, v25, 3, 1
    v_lshl_add_u32 v27, v28, 2, v27
    v_bfe_u32 v28, v25, 2, 1
    v_lshl_add_u32 v27, v28, 3, v27
    v_mul_u32_u24 v27, 1280, v27
    v_lshl_add_u32 v27, v26, 4, v27
    v_add_u32 v18, s29, v27
    v_add_u32 v24, 192, v1
    v_mul_u32_u24 v25, 6554, v24
    v_lshrrev_b32 v25, 16, v25
    v_mul_u32_u24 v26, 10, v25
    v_sub_u32 v26, v24, v26
    v_and_b32 v27, 0x13, v25
    v_bfe_u32 v28, v25, 3, 1
    v_lshl_add_u32 v27, v28, 2, v27
    v_bfe_u32 v28, v25, 2, 1
    v_lshl_add_u32 v27, v28, 3, v27
    v_mul_u32_u24 v27, 1280, v27
    v_lshl_add_u32 v27, v26, 4, v27
    v_add_u32 v19, s29, v27
    v_add_u32 v24, 256, v1
    v_mul_u32_u24 v25, 6554, v24
    v_lshrrev_b32 v25, 16, v25
    v_mul_u32_u24 v26, 10, v25
    v_sub_u32 v26, v24, v26
    v_and_b32 v27, 0x13, v25
    v_bfe_u32 v28, v25, 3, 1
    v_lshl_add_u32 v27, v28, 2, v27
    v_bfe_u32 v28, v25, 2, 1
    v_lshl_add_u32 v27, v28, 3, v27
    v_mul_u32_u24 v27, 1280, v27
    v_lshl_add_u32 v27, v26, 4, v27
    v_add_u32 v20, s29, v27
    s_waitcnt lgkmcnt(0)
    s_mov_b32 s8, s86
    s_mov_b32 s9, s87
    s_and_b32 s9, s9, 0xffff
    s_mov_b32 s10, 34340864
    s_mov_b32 s11, 0x20000
    s_mov_b32 s12, 0
    s_mov_b32 s13, 0
    s_mov_b32 s60, s58
    s_mov_b32 s61, s59
    s_and_b32 s61, s61, 0xffff
    s_mov_b32 s62, 256
    s_mov_b32 s63, 0x20000
    s_cmp_lg_u32 s2, 0
    s_cbranch_scc1 interleave_layers__grouped_kv_mqa__mixer_channel_mlp__prompt_kernel_nn1
    s_cmp_lg_u32 s3, 5
    s_cbranch_scc1 interleave_layers__grouped_kv_mqa__mixer_channel_mlp__prompt_kernel_nn1
    s_memrealtime s[28:29]
    s_waitcnt lgkmcnt(0)
    s_lshl_b32 s28, s28, 6
    s_or_b32 s28, s28, 1
    v_mov_b32 v201, s28
    v_mov_b32 v200, 0
    s_mov_b64 exec, 1
    buffer_store_dword v201, v200, s[60:63], 0 offen sc1
    s_mov_b64 exec, -1
interleave_layers__grouped_kv_mqa__mixer_channel_mlp__prompt_kernel_nn1:
    s_mul_i32 s40, s7, 7
    s_sub_u32 s28, s7, 6
    s_max_i32 s28, s28, 0
    s_sub_u32 s40, s40, s28
    s_cmp_ge_u32 s7, 6
    s_cselect_b32 s41, 6, 7
    s_add_u32 s40, s40, s3
    s_mov_b32 s24, s64
    s_mov_b32 s25, s65
    s_and_b32 s25, s25, 0xffff
    s_mov_b32 s26, 2621440
    s_mov_b32 s27, 0x20000
    s_movk_i32 s28, 1280
    v_mul_lo_u32 v144, v14, s28
    v_lshl_add_u32 v145, v3, 4, v144
    s_mul_i32 s29, s5, 640
    v_add_u32 v145, s29, v145
    buffer_load_dwordx4 v[24:27], v145, s[24:27], 0 offen offset:0
    buffer_load_dwordx4 v[28:31], v145, s[24:27], 0 offen offset:64
    buffer_load_dwordx4 v[32:35], v145, s[24:27], 0 offen offset:128
    buffer_load_dwordx4 v[36:39], v145, s[24:27], 0 offen offset:192
    buffer_load_dwordx4 v[40:43], v145, s[24:27], 0 offen offset:256
    buffer_load_dwordx4 v[44:47], v145, s[24:27], 0 offen offset:320
    buffer_load_dwordx4 v[48:51], v145, s[24:27], 0 offen offset:384
    buffer_load_dwordx4 v[52:55], v145, s[24:27], 0 offen offset:448
    buffer_load_dwordx4 v[56:59], v145, s[24:27], 0 offen offset:512
    buffer_load_dwordx4 v[60:63], v145, s[24:27], 0 offen offset:576
    v_lshl_add_u32 v145, v3, 3, v144
    s_mul_i32 s29, s7, 160
    s_mul_i32 s30, s5, 96
    s_add_u32 s29, s29, s30
    v_add_u32 v145, s29, v145
    buffer_load_dwordx2 v[8:9], v145, s[24:27], 0 offen offset:0
    buffer_load_dwordx2 v[10:11], v145, s[24:27], 0 offen offset:32
    buffer_load_dwordx2 v[12:13], v145, s[24:27], 0 offen offset:64
    s_lshr_b32 s28, s7, 1
    s_cmp_eq_u32 s28, s4
    s_cbranch_scc1 interleave_layers__grouped_kv_mqa__mixer_channel_mlp__prompt_kernel_kvw2
    s_mov_b32 s43, s3
    s_cmp_gt_u32 s3, s28
    s_cselect_b32 s29, 1, 0
    s_sub_u32 s43, s43, s29
    s_add_u32 s28, s28, 4
    s_cmp_gt_u32 s3, s28
    s_cselect_b32 s29, 1, 0
    s_sub_u32 s43, s43, s29
    s_mov_b32 s16, s66
    s_mov_b32 s17, s67
    s_and_b32 s17, s17, 0xffff
    s_mov_b32 s18, 819200
    s_mov_b32 s19, 0x20000
    s_waitcnt vmcnt(8)
    s_add_u32 s28, s43, 0
    s_mul_i32 s29, s28, 40960
    s_mul_i32 s30, s28, 5120
    s_mov_b32 m0, s30
    s_nop 0
    buffer_load_dwordx4 v16, s[16:19], s29 offen lds
    s_add_u32 s30, s30, 1024
    s_mov_b32 m0, s30
    s_nop 0
    buffer_load_dwordx4 v17, s[16:19], s29 offen lds
    s_add_u32 s30, s30, 1024
    s_mov_b32 m0, s30
    s_nop 0
    buffer_load_dwordx4 v18, s[16:19], s29 offen lds
    s_add_u32 s30, s30, 1024
    s_mov_b32 m0, s30
    s_nop 0
    buffer_load_dwordx4 v19, s[16:19], s29 offen lds
    s_add_u32 s30, s30, 1024
    s_mov_b32 m0, s30
    s_nop 0
    buffer_load_dwordx4 v20, s[16:19], s29 offen lds
interleave_layers__grouped_kv_mqa__mixer_channel_mlp__prompt_kernel_wq4:
    s_add_u32 s28, s43, 6
    s_mul_i32 s29, s28, 40960
    s_mul_i32 s30, s28, 5120
    s_mov_b32 m0, s30
    s_nop 0
    buffer_load_dwordx4 v16, s[16:19], s29 offen lds
    s_add_u32 s30, s30, 1024
    s_mov_b32 m0, s30
    s_nop 0
    buffer_load_dwordx4 v17, s[16:19], s29 offen lds
    s_add_u32 s30, s30, 1024
    s_mov_b32 m0, s30
    s_nop 0
    buffer_load_dwordx4 v18, s[16:19], s29 offen lds
    s_add_u32 s30, s30, 1024
    s_mov_b32 m0, s30
    s_nop 0
    buffer_load_dwordx4 v19, s[16:19], s29 offen lds
    s_add_u32 s30, s30, 1024
    s_mov_b32 m0, s30
    s_nop 0
    buffer_load_dwordx4 v20, s[16:19], s29 offen lds
interleave_layers__grouped_kv_mqa__mixer_channel_mlp__prompt_kernel_wq5:
    s_add_u32 s28, s43, 12
    s_mul_i32 s29, s28, 40960
    s_mul_i32 s30, s28, 5120
    s_mov_b32 m0, s30
    s_nop 0
    buffer_load_dwordx4 v16, s[16:19], s29 offen lds
    s_add_u32 s30, s30, 1024
    s_mov_b32 m0, s30
    s_nop 0
    buffer_load_dwordx4 v17, s[16:19], s29 offen lds
    s_add_u32 s30, s30, 1024
    s_mov_b32 m0, s30
    s_nop 0
    buffer_load_dwordx4 v18, s[16:19], s29 offen lds
    s_add_u32 s30, s30, 1024
    s_mov_b32 m0, s30
    s_nop 0
    buffer_load_dwordx4 v19, s[16:19], s29 offen lds
    s_add_u32 s30, s30, 1024
    s_mov_b32 m0, s30
    s_nop 0
    buffer_load_dwordx4 v20, s[16:19], s29 offen lds
interleave_layers__grouped_kv_mqa__mixer_channel_mlp__prompt_kernel_wq6:
    s_add_u32 s28, s43, 18
    s_cmp_ge_u32 s28, 20
    s_cbranch_scc1 interleave_layers__grouped_kv_mqa__mixer_channel_mlp__prompt_kernel_wq7
    s_mul_i32 s29, s28, 40960
    s_mul_i32 s30, s28, 5120
    s_mov_b32 m0, s30
    s_nop 0
    buffer_load_dwordx4 v16, s[16:19], s29 offen lds
    s_add_u32 s30, s30, 1024
    s_mov_b32 m0, s30
    s_nop 0
    buffer_load_dwordx4 v17, s[16:19], s29 offen lds
    s_add_u32 s30, s30, 1024
    s_mov_b32 m0, s30
    s_nop 0
    buffer_load_dwordx4 v18, s[16:19], s29 offen lds
    s_add_u32 s30, s30, 1024
    s_mov_b32 m0, s30
    s_nop 0
    buffer_load_dwordx4 v19, s[16:19], s29 offen lds
    s_add_u32 s30, s30, 1024
    s_mov_b32 m0, s30
    s_nop 0
    buffer_load_dwordx4 v20, s[16:19], s29 offen lds
interleave_layers__grouped_kv_mqa__mixer_channel_mlp__prompt_kernel_wq7:
    s_branch interleave_layers__grouped_kv_mqa__mixer_channel_mlp__prompt_kernel_pj3
interleave_layers__grouped_kv_mqa__mixer_channel_mlp__prompt_kernel_kvw2:
    s_mov_b32 s43, 7
    s_and_b32 s28, s7, 1
    s_cmp_eq_u32 s28, 0
    s_cselect_b32 s30, s68, s70
    s_cselect_b32 s31, s69, s71
    s_mov_b32 s20, s30
    s_mov_b32 s21, s31
    s_and_b32 s21, s21, 0xffff
    s_mov_b32 s22, 25600
    s_mov_b32 s23, 0x20000
    s_mul_i32 s29, s5, 12288
    s_add_u32 m0, s29, 102400
    s_nop 0
    buffer_load_dwordx4 v4, s[20:23], s29 offen lds
    s_add_u32 s29, s29, 1024
    s_add_u32 m0, s29, 102400
    s_nop 0
    buffer_load_dwordx4 v4, s[20:23], s29 offen lds
    s_add_u32 s29, s29, 1024
    s_add_u32 m0, s29, 102400
    s_nop 0
    buffer_load_dwordx4 v4, s[20:23], s29 offen lds
    s_add_u32 s29, s29, 1024
    s_add_u32 m0, s29, 102400
    s_nop 0
    buffer_load_dwordx4 v4, s[20:23], s29 offen lds
    s_add_u32 s29, s29, 1024
    s_add_u32 m0, s29, 102400
    s_nop 0
    buffer_load_dwordx4 v4, s[20:23], s29 offen lds
    s_add_u32 s29, s29, 1024
    s_add_u32 m0, s29, 102400
    s_nop 0
    buffer_load_dwordx4 v4, s[20:23], s29 offen lds
    s_add_u32 s29, s29, 1024
    s_add_u32 m0, s29, 102400
    s_nop 0
    buffer_load_dwordx4 v4, s[20:23], s29 offen lds
    s_add_u32 s29, s29, 1024
    s_add_u32 m0, s29, 102400
    s_nop 0
    buffer_load_dwordx4 v4, s[20:23], s29 offen lds
    s_add_u32 s29, s29, 1024
    s_add_u32 m0, s29, 102400
    s_nop 0
    buffer_load_dwordx4 v4, s[20:23], s29 offen lds
    s_add_u32 s29, s29, 1024
    s_add_u32 m0, s29, 102400
    s_nop 0
    buffer_load_dwordx4 v4, s[20:23], s29 offen lds
    s_add_u32 s29, s29, 1024
    s_add_u32 m0, s29, 102400
    s_nop 0
    buffer_load_dwordx4 v4, s[20:23], s29 offen lds
    s_add_u32 s29, s29, 1024
    s_add_u32 m0, s29, 102400
    s_nop 0
    buffer_load_dwordx4 v4, s[20:23], s29 offen lds
    s_add_u32 s29, s29, 1024
    s_add_u32 m0, s29, 102400
    s_nop 0
    buffer_load_dwordx4 v4, s[20:23], s29 offen lds
    s_add_u32 s29, s29, 1024
interleave_layers__grouped_kv_mqa__mixer_channel_mlp__prompt_kernel_pj3:
mega_layer:
    v_mov_b32 v140, 0x3f803f80
    v_mov_b32 v141, 0x3f803f80
    v_mov_b32 v142, 0x3f803f80
    v_mov_b32 v143, 0x3f803f80
    s_cmp_eq_u32 s12, 0
    s_cbranch_scc1 interleave_layers__grouped_kv_mqa__mixer_channel_mlp__prompt_kernel_x08
    s_lshl_b32 s28, s6, 2
    s_add_u32 s28, s28, s4
    s_mul_i32 s28, s28, 20
    s_mul_i32 s29, s5, 10
    s_add_u32 s28, s28, s29
    s_lshl_b32 s28, s28, 10
    s_add_u32 s28, s28, 25657344
    buffer_load_dwordx4 v[24:27], v4, s[8:11], s28 offen offset:0 sc1
    buffer_load_dwordx4 v[28:31], v4, s[8:11], s28 offen offset:1024 sc1
    buffer_load_dwordx4 v[32:35], v4, s[8:11], s28 offen offset:2048 sc1
    buffer_load_dwordx4 v[36:39], v4, s[8:11], s28 offen offset:3072 sc1
    s_add_u32 s28, s28, 4096
    buffer_load_dwordx4 v[40:43], v4, s[8:11], s28 offen offset:0 sc1
    buffer_load_dwordx4 v[44:47], v4, s[8:11], s28 offen offset:1024 sc1
    buffer_load_dwordx4 v[48:51], v4, s[8:11], s28 offen offset:2048 sc1
    buffer_load_dwordx4 v[52:55], v4, s[8:11], s28 offen offset:3072 sc1
    s_add_u32 s28, s28, 4096
    buffer_load_dwordx4 v[56:59], v4, s[8:11], s28 offen offset:0 sc1
    buffer_load_dwordx4 v[60:63], v4, s[8:11], s28 offen offset:1024 sc1
    s_waitcnt vmcnt(9)
    s_barrier
    s_branch interleave_layers__grouped_kv_mqa__mixer_channel_mlp__prompt_kernel_x19
interleave_layers__grouped_kv_mqa__mixer_channel_mlp__prompt_kernel_x08:
    s_lshr_b32 s28, s7, 1
    s_cmp_lg_u32 s28, s4
    s_cbranch_scc1 interleave_layers__grouped_kv_mqa__mixer_channel_mlp__prompt_kernel_nk10
    s_waitcnt vmcnt(0)
    v_mov_b32 v200, 0
    buffer_load_dword v201, v200, s[60:63], 0 offen sc1
interleave_layers__grouped_kv_mqa__mixer_channel_mlp__prompt_kernel_nk10:
interleave_layers__grouped_kv_mqa__mixer_channel_mlp__prompt_kernel_x19:
    s_lshr_b32 s28, s7, 1
    s_cmp_lg_u32 s28, s4
    s_cbranch_scc1 interleave_layers__grouped_kv_mqa__mixer_channel_mlp__prompt_kernel_nokv11
    v_lshrrev_b32 v148, 2, v2
    v_lshl_add_u32 v148, v3, 3, v148
    v_mul_u32_u24 v148, 40, v148
    v_and_b32 v149, 3, v1
    v_lshl_add_u32 v148, v149, 3, v148
    s_mul_i32 s28, s5, 12800
    s_add_u32 s28, s28, 102400
    v_add_u32 v148, s28, v148
    s_and_b32 s28, s7, 1
    s_lshl_b32 s28, s28, 1
    s_add_u32 s28, s28, s12
    s_cmp_eq_u32 s28, 0
    s_cbranch_scc1 interleave_layers__grouped_kv_mqa__mixer_channel_mlp__prompt_kernel_kvv14
    s_cmp_eq_u32 s28, 1
    s_cbranch_scc1 interleave_layers__grouped_kv_mqa__mixer_channel_mlp__prompt_kernel_kvv13
    s_cmp_eq_u32 s28, 2
    s_cbranch_scc1 interleave_layers__grouped_kv_mqa__mixer_channel_mlp__prompt_kernel_kvv16
    s_branch interleave_layers__grouped_kv_mqa__mixer_channel_mlp__prompt_kernel_kvv15
interleave_layers__grouped_kv_mqa__mixer_channel_mlp__prompt_kernel_kvv13:
    ds_read_b64_tr_b16 v[64:65], v148 offset:0
    ds_read_b64_tr_b16 v[66:67], v148 offset:160
    ds_read_b64_tr_b16 v[68:69], v148 offset:32
    ds_read_b64_tr_b16 v[70:71], v148 offset:192
    ds_read_b64_tr_b16 v[72:73], v148 offset:1280
    ds_read_b64_tr_b16 v[74:75], v148 offset:1440
    ds_read_b64_tr_b16 v[76:77], v148 offset:1312
    ds_read_b64_tr_b16 v[78:79], v148 offset:1472
    ds_read_b64_tr_b16 v[80:81], v148 offset:2560
    ds_read_b64_tr_b16 v[82:83], v148 offset:2720
    ds_read_b64_tr_b16 v[84:85], v148 offset:2592
    ds_read_b64_tr_b16 v[86:87], v148 offset:2752
    ds_read_b64_tr_b16 v[88:89], v148 offset:3840
    ds_read_b64_tr_b16 v[90:91], v148 offset:4000
    ds_read_b64_tr_b16 v[92:93], v148 offset:3872
    ds_read_b64_tr_b16 v[94:95], v148 offset:4032
    s_waitcnt lgkmcnt(14) vmcnt(9)
    v_mfma_f32_16x16x32_bf16 v[124:127], v[64:67], v[24:27], 0
    v_mfma_f32_16x16x32_bf16 v[176:179], v[140:143], v[24:27], 0
    ds_read_b64_tr_b16 v[64:65], v148 offset:5120
    ds_read_b64_tr_b16 v[66:67], v148 offset:5280
    s_waitcnt lgkmcnt(14)
    v_mfma_f32_16x16x32_bf16 v[128:131], v[68:71], v[24:27], 0
    v_mfma_f32_16x16x32_bf16 v[180:183], v[24:27], v[24:27], 0
    ds_read_b64_tr_b16 v[68:69], v148 offset:5152
    ds_read_b64_tr_b16 v[70:71], v148 offset:5312
    s_waitcnt lgkmcnt(14) vmcnt(8)
    v_mfma_f32_16x16x32_bf16 v[124:127], v[72:75], v[28:31], v[124:127]
    v_mfma_f32_16x16x32_bf16 v[176:179], v[140:143], v[28:31], v[176:179]
    ds_read_b64_tr_b16 v[72:73], v148 offset:6400
    ds_read_b64_tr_b16 v[74:75], v148 offset:6560
    s_waitcnt lgkmcnt(14)
    v_mfma_f32_16x16x32_bf16 v[128:131], v[76:79], v[28:31], v[128:131]
    v_mfma_f32_16x16x32_bf16 v[180:183], v[28:31], v[28:31], v[180:183]
    ds_read_b64_tr_b16 v[76:77], v148 offset:6432
    ds_read_b64_tr_b16 v[78:79], v148 offset:6592
    s_waitcnt lgkmcnt(14) vmcnt(7)
    v_mfma_f32_16x16x32_bf16 v[124:127], v[80:83], v[32:35], v[124:127]
    v_mfma_f32_16x16x32_bf16 v[176:179], v[140:143], v[32:35], v[176:179]
    ds_read_b64_tr_b16 v[80:81], v148 offset:7680
    ds_read_b64_tr_b16 v[82:83], v148 offset:7840
    s_waitcnt lgkmcnt(14)
    v_mfma_f32_16x16x32_bf16 v[128:131], v[84:87], v[32:35], v[128:131]
    v_mfma_f32_16x16x32_bf16 v[180:183], v[32:35], v[32:35], v[180:183]
    ds_read_b64_tr_b16 v[84:85], v148 offset:7712
    ds_read_b64_tr_b16 v[86:87], v148 offset:7872
    s_waitcnt lgkmcnt(14) vmcnt(6)
    v_mfma_f32_16x16x32_bf16 v[124:127], v[88:91], v[36:39], v[124:127]
    v_mfma_f32_16x16x32_bf16 v[176:179], v[140:143], v[36:39], v[176:179]
    ds_read_b64_tr_b16 v[88:89], v148 offset:8960
    ds_read_b64_tr_b16 v[90:91], v148 offset:9120
    s_waitcnt lgkmcnt(14)
    v_mfma_f32_16x16x32_bf16 v[128:131], v[92:95], v[36:39], v[128:131]
    v_mfma_f32_16x16x32_bf16 v[180:183], v[36:39], v[36:39], v[180:183]
    ds_read_b64_tr_b16 v[92:93], v148 offset:8992
    ds_read_b64_tr_b16 v[94:95], v148 offset:9152
    s_waitcnt lgkmcnt(14) vmcnt(5)
    v_mfma_f32_16x16x32_bf16 v[124:127], v[64:67], v[40:43], v[124:127]
    v_mfma_f32_16x16x32_bf16 v[176:179], v[140:143], v[40:43], v[176:179]
    ds_read_b64_tr_b16 v[64:65], v148 offset:10240
    ds_read_b64_tr_b16 v[66:67], v148 offset:10400
    s_waitcnt lgkmcnt(14)
    v_mfma_f32_16x16x32_bf16 v[128:131], v[68:71], v[40:43], v[128:131]
    v_mfma_f32_16x16x32_bf16 v[180:183], v[40:43], v[40:43], v[180:183]
    ds_read_b64_tr_b16 v[68:69], v148 offset:10272
    ds_read_b64_tr_b16 v[70:71], v148 offset:10432
    s_waitcnt lgkmcnt(14) vmcnt(4)
    v_mfma_f32_16x16x32_bf16 v[124:127], v[72:75], v[44:47], v[124:127]
    v_mfma_f32_16x16x32_bf16 v[176:179], v[140:143], v[44:47], v[176:179]
    ds_read_b64_tr_b16 v[72:73], v148 offset:11520
    ds_read_b64_tr_b16 v[74:75], v148 offset:11680
    s_waitcnt lgkmcnt(14)
    v_mfma_f32_16x16x32_bf16 v[128:131], v[76:79], v[44:47], v[128:131]
    v_mfma_f32_16x16x32_bf16 v[180:183], v[44:47], v[44:47], v[180:183]
    ds_read_b64_tr_b16 v[76:77], v148 offset:11552
    ds_read_b64_tr_b16 v[78:79], v148 offset:11712
    s_waitcnt lgkmcnt(14) vmcnt(3)
    v_mfma_f32_16x16x32_bf16 v[124:127], v[80:83], v[48:51], v[124:127]
    v_mfma_f32_16x16x32_bf16 v[176:179], v[140:143], v[48:51], v[176:179]
    s_waitcnt lgkmcnt(12)
    v_mfma_f32_16x16x32_bf16 v[128:131], v[84:87], v[48:51], v[128:131]
    v_mfma_f32_16x16x32_bf16 v[180:183], v[48:51], v[48:51], v[180:183]
    s_waitcnt lgkmcnt(10) vmcnt(2)
    v_mfma_f32_16x16x32_bf16 v[124:127], v[88:91], v[52:55], v[124:127]
    v_mfma_f32_16x16x32_bf16 v[176:179], v[140:143], v[52:55], v[176:179]
    s_waitcnt lgkmcnt(8)
    v_mfma_f32_16x16x32_bf16 v[128:131], v[92:95], v[52:55], v[128:131]
    v_mfma_f32_16x16x32_bf16 v[180:183], v[52:55], v[52:55], v[180:183]
    s_waitcnt lgkmcnt(6) vmcnt(1)
    v_mfma_f32_16x16x32_bf16 v[124:127], v[64:67], v[56:59], v[124:127]
    v_mfma_f32_16x16x32_bf16 v[176:179], v[140:143], v[56:59], v[176:179]
    s_waitcnt lgkmcnt(4)
    v_mfma_f32_16x16x32_bf16 v[128:131], v[68:71], v[56:59], v[128:131]
    v_mfma_f32_16x16x32_bf16 v[180:183], v[56:59], v[56:59], v[180:183]
    s_waitcnt lgkmcnt(2) vmcnt(0)
    v_mfma_f32_16x16x32_bf16 v[124:127], v[72:75], v[60:63], v[124:127]
    v_mfma_f32_16x16x32_bf16 v[176:179], v[140:143], v[60:63], v[176:179]
    s_waitcnt lgkmcnt(0)
    v_mfma_f32_16x16x32_bf16 v[128:131], v[76:79], v[60:63], v[128:131]
    v_mfma_f32_16x16x32_bf16 v[180:183], v[60:63], v[60:63], v[180:183]
    s_branch interleave_layers__grouped_kv_mqa__mixer_channel_mlp__prompt_kernel_kvd12
interleave_layers__grouped_kv_mqa__mixer_channel_mlp__prompt_kernel_kvv14:
    ds_read_b64_tr_b16 v[64:65], v148 offset:0
    ds_read_b64_tr_b16 v[66:67], v148 offset:160
    ds_read_b64_tr_b16 v[68:69], v148 offset:32
    ds_read_b64_tr_b16 v[70:71], v148 offset:192
    ds_read_b64_tr_b16 v[72:73], v148 offset:1280
    ds_read_b64_tr_b16 v[74:75], v148 offset:1440
    ds_read_b64_tr_b16 v[76:77], v148 offset:1312
    ds_read_b64_tr_b16 v[78:79], v148 offset:1472
    ds_read_b64_tr_b16 v[80:81], v148 offset:2560
    ds_read_b64_tr_b16 v[82:83], v148 offset:2720
    ds_read_b64_tr_b16 v[84:85], v148 offset:2592
    ds_read_b64_tr_b16 v[86:87], v148 offset:2752
    ds_read_b64_tr_b16 v[88:89], v148 offset:3840
    ds_read_b64_tr_b16 v[90:91], v148 offset:4000
    ds_read_b64_tr_b16 v[92:93], v148 offset:3872
    ds_read_b64_tr_b16 v[94:95], v148 offset:4032
    s_waitcnt lgkmcnt(14)
    v_mfma_f32_16x16x32_bf16 v[124:127], v[64:67], v[24:27], 0
    v_mfma_f32_16x16x32_bf16 v[132:135], v[64:67], v[140:143], 0
    v_mfma_f32_16x16x32_bf16 v[176:179], v[140:143], v[24:27], 0
    ds_read_b64_tr_b16 v[64:65], v148 offset:5120
    ds_read_b64_tr_b16 v[66:67], v148 offset:5280
    s_waitcnt lgkmcnt(14)
    v_mfma_f32_16x16x32_bf16 v[128:131], v[68:71], v[24:27], 0
    v_mfma_f32_16x16x32_bf16 v[136:139], v[68:71], v[140:143], 0
    v_mfma_f32_16x16x32_bf16 v[180:183], v[24:27], v[24:27], 0
    ds_read_b64_tr_b16 v[68:69], v148 offset:5152
    ds_read_b64_tr_b16 v[70:71], v148 offset:5312
    s_waitcnt lgkmcnt(14)
    v_mfma_f32_16x16x32_bf16 v[124:127], v[72:75], v[28:31], v[124:127]
    v_mfma_f32_16x16x32_bf16 v[132:135], v[72:75], v[140:143], v[132:135]
    v_mfma_f32_16x16x32_bf16 v[176:179], v[140:143], v[28:31], v[176:179]
    ds_read_b64_tr_b16 v[72:73], v148 offset:6400
    ds_read_b64_tr_b16 v[74:75], v148 offset:6560
    s_waitcnt lgkmcnt(14)
    v_mfma_f32_16x16x32_bf16 v[128:131], v[76:79], v[28:31], v[128:131]
    v_mfma_f32_16x16x32_bf16 v[136:139], v[76:79], v[140:143], v[136:139]
    v_mfma_f32_16x16x32_bf16 v[180:183], v[28:31], v[28:31], v[180:183]
    ds_read_b64_tr_b16 v[76:77], v148 offset:6432
    ds_read_b64_tr_b16 v[78:79], v148 offset:6592
    s_waitcnt lgkmcnt(14)
    v_mfma_f32_16x16x32_bf16 v[124:127], v[80:83], v[32:35], v[124:127]
    v_mfma_f32_16x16x32_bf16 v[132:135], v[80:83], v[140:143], v[132:135]
    v_mfma_f32_16x16x32_bf16 v[176:179], v[140:143], v[32:35], v[176:179]
    ds_read_b64_tr_b16 v[80:81], v148 offset:7680
    ds_read_b64_tr_b16 v[82:83], v148 offset:7840
    s_waitcnt lgkmcnt(14)
    v_mfma_f32_16x16x32_bf16 v[128:131], v[84:87], v[32:35], v[128:131]
    v_mfma_f32_16x16x32_bf16 v[136:139], v[84:87], v[140:143], v[136:139]
    v_mfma_f32_16x16x32_bf16 v[180:183], v[32:35], v[32:35], v[180:183]
    ds_read_b64_tr_b16 v[84:85], v148 offset:7712
    ds_read_b64_tr_b16 v[86:87], v148 offset:7872
    s_waitcnt lgkmcnt(14)
    v_mfma_f32_16x16x32_bf16 v[124:127], v[88:91], v[36:39], v[124:127]
    v_mfma_f32_16x16x32_bf16 v[132:135], v[88:91], v[140:143], v[132:135]
    v_mfma_f32_16x16x32_bf16 v[176:179], v[140:143], v[36:39], v[176:179]
    ds_read_b64_tr_b16 v[88:89], v148 offset:8960
    ds_read_b64_tr_b16 v[90:91], v148 offset:9120
    s_waitcnt lgkmcnt(14)
    v_mfma_f32_16x16x32_bf16 v[128:131], v[92:95], v[36:39], v[128:131]
    v_mfma_f32_16x16x32_bf16 v[136:139], v[92:95], v[140:143], v[136:139]
    v_mfma_f32_16x16x32_bf16 v[180:183], v[36:39], v[36:39], v[180:183]
    ds_read_b64_tr_b16 v[92:93], v148 offset:8992
    ds_read_b64_tr_b16 v[94:95], v148 offset:9152
    s_waitcnt lgkmcnt(14)
    v_mfma_f32_16x16x32_bf16 v[124:127], v[64:67], v[40:43], v[124:127]
    v_mfma_f32_16x16x32_bf16 v[132:135], v[64:67], v[140:143], v[132:135]
    v_mfma_f32_16x16x32_bf16 v[176:179], v[140:143], v[40:43], v[176:179]
    ds_read_b64_tr_b16 v[64:65], v148 offset:10240
    ds_read_b64_tr_b16 v[66:67], v148 offset:10400
    s_waitcnt lgkmcnt(14)
    v_mfma_f32_16x16x32_bf16 v[128:131], v[68:71], v[40:43], v[128:131]
    v_mfma_f32_16x16x32_bf16 v[136:139], v[68:71], v[140:143], v[136:139]
    v_mfma_f32_16x16x32_bf16 v[180:183], v[40:43], v[40:43], v[180:183]
    ds_read_b64_tr_b16 v[68:69], v148 offset:10272
    ds_read_b64_tr_b16 v[70:71], v148 offset:10432
    s_waitcnt lgkmcnt(14)
    v_mfma_f32_16x16x32_bf16 v[124:127], v[72:75], v[44:47], v[124:127]
    v_mfma_f32_16x16x32_bf16 v[132:135], v[72:75], v[140:143], v[132:135]
    v_mfma_f32_16x16x32_bf16 v[176:179], v[140:143], v[44:47], v[176:179]
    ds_read_b64_tr_b16 v[72:73], v148 offset:11520
    ds_read_b64_tr_b16 v[74:75], v148 offset:11680
    s_waitcnt lgkmcnt(14)
    v_mfma_f32_16x16x32_bf16 v[128:131], v[76:79], v[44:47], v[128:131]
    v_mfma_f32_16x16x32_bf16 v[136:139], v[76:79], v[140:143], v[136:139]
    v_mfma_f32_16x16x32_bf16 v[180:183], v[44:47], v[44:47], v[180:183]
    ds_read_b64_tr_b16 v[76:77], v148 offset:11552
    ds_read_b64_tr_b16 v[78:79], v148 offset:11712
    s_waitcnt lgkmcnt(14)
    v_mfma_f32_16x16x32_bf16 v[124:127], v[80:83], v[48:51], v[124:127]
    v_mfma_f32_16x16x32_bf16 v[132:135], v[80:83], v[140:143], v[132:135]
    v_mfma_f32_16x16x32_bf16 v[176:179], v[140:143], v[48:51], v[176:179]
    s_waitcnt lgkmcnt(12)
    v_mfma_f32_16x16x32_bf16 v[128:131], v[84:87], v[48:51], v[128:131]
    v_mfma_f32_16x16x32_bf16 v[136:139], v[84:87], v[140:143], v[136:139]
    v_mfma_f32_16x16x32_bf16 v[180:183], v[48:51], v[48:51], v[180:183]
    s_waitcnt lgkmcnt(10)
    v_mfma_f32_16x16x32_bf16 v[124:127], v[88:91], v[52:55], v[124:127]
    v_mfma_f32_16x16x32_bf16 v[132:135], v[88:91], v[140:143], v[132:135]
    v_mfma_f32_16x16x32_bf16 v[176:179], v[140:143], v[52:55], v[176:179]
    s_waitcnt lgkmcnt(8)
    v_mfma_f32_16x16x32_bf16 v[128:131], v[92:95], v[52:55], v[128:131]
    v_mfma_f32_16x16x32_bf16 v[136:139], v[92:95], v[140:143], v[136:139]
    v_mfma_f32_16x16x32_bf16 v[180:183], v[52:55], v[52:55], v[180:183]
    s_waitcnt lgkmcnt(6)
    v_mfma_f32_16x16x32_bf16 v[124:127], v[64:67], v[56:59], v[124:127]
    v_mfma_f32_16x16x32_bf16 v[132:135], v[64:67], v[140:143], v[132:135]
    v_mfma_f32_16x16x32_bf16 v[176:179], v[140:143], v[56:59], v[176:179]
    s_waitcnt lgkmcnt(4)
    v_mfma_f32_16x16x32_bf16 v[128:131], v[68:71], v[56:59], v[128:131]
    v_mfma_f32_16x16x32_bf16 v[136:139], v[68:71], v[140:143], v[136:139]
    v_mfma_f32_16x16x32_bf16 v[180:183], v[56:59], v[56:59], v[180:183]
    s_waitcnt lgkmcnt(2)
    v_mfma_f32_16x16x32_bf16 v[124:127], v[72:75], v[60:63], v[124:127]
    v_mfma_f32_16x16x32_bf16 v[132:135], v[72:75], v[140:143], v[132:135]
    v_mfma_f32_16x16x32_bf16 v[176:179], v[140:143], v[60:63], v[176:179]
    s_waitcnt lgkmcnt(0)
    v_mfma_f32_16x16x32_bf16 v[128:131], v[76:79], v[60:63], v[128:131]
    v_mfma_f32_16x16x32_bf16 v[136:139], v[76:79], v[140:143], v[136:139]
    v_mfma_f32_16x16x32_bf16 v[180:183], v[60:63], v[60:63], v[180:183]
    s_branch interleave_layers__grouped_kv_mqa__mixer_channel_mlp__prompt_kernel_kvd12
interleave_layers__grouped_kv_mqa__mixer_channel_mlp__prompt_kernel_kvv15:
    ds_read_b64_tr_b16 v[64:65], v148 offset:0
    ds_read_b64_tr_b16 v[66:67], v148 offset:160
    ds_read_b64_tr_b16 v[68:69], v148 offset:32
    ds_read_b64_tr_b16 v[70:71], v148 offset:192
    ds_read_b64_tr_b16 v[72:73], v148 offset:1280
    ds_read_b64_tr_b16 v[74:75], v148 offset:1440
    ds_read_b64_tr_b16 v[76:77], v148 offset:1312
    ds_read_b64_tr_b16 v[78:79], v148 offset:1472
    ds_read_b64_tr_b16 v[80:81], v148 offset:2560
    ds_read_b64_tr_b16 v[82:83], v148 offset:2720
    ds_read_b64_tr_b16 v[84:85], v148 offset:2592
    ds_read_b64_tr_b16 v[86:87], v148 offset:2752
    ds_read_b64_tr_b16 v[88:89], v148 offset:3840
    ds_read_b64_tr_b16 v[90:91], v148 offset:4000
    ds_read_b64_tr_b16 v[92:93], v148 offset:3872
    ds_read_b64_tr_b16 v[94:95], v148 offset:4032
    s_waitcnt lgkmcnt(14) vmcnt(9)
    v_mfma_f32_16x16x32_bf16 v[124:127], v[24:27], v[64:67], 0
    v_mfma_f32_16x16x32_bf16 v[176:179], v[140:143], v[24:27], 0
    ds_read_b64_tr_b16 v[64:65], v148 offset:5120
    ds_read_b64_tr_b16 v[66:67], v148 offset:5280
    s_waitcnt lgkmcnt(14)
    v_mfma_f32_16x16x32_bf16 v[128:131], v[24:27], v[68:71], 0
    v_mfma_f32_16x16x32_bf16 v[180:183], v[24:27], v[24:27], 0
    ds_read_b64_tr_b16 v[68:69], v148 offset:5152
    ds_read_b64_tr_b16 v[70:71], v148 offset:5312
    s_waitcnt lgkmcnt(14) vmcnt(8)
    v_mfma_f32_16x16x32_bf16 v[124:127], v[28:31], v[72:75], v[124:127]
    v_mfma_f32_16x16x32_bf16 v[176:179], v[140:143], v[28:31], v[176:179]
    ds_read_b64_tr_b16 v[72:73], v148 offset:6400
    ds_read_b64_tr_b16 v[74:75], v148 offset:6560
    s_waitcnt lgkmcnt(14)
    v_mfma_f32_16x16x32_bf16 v[128:131], v[28:31], v[76:79], v[128:131]
    v_mfma_f32_16x16x32_bf16 v[180:183], v[28:31], v[28:31], v[180:183]
    ds_read_b64_tr_b16 v[76:77], v148 offset:6432
    ds_read_b64_tr_b16 v[78:79], v148 offset:6592
    s_waitcnt lgkmcnt(14) vmcnt(7)
    v_mfma_f32_16x16x32_bf16 v[124:127], v[32:35], v[80:83], v[124:127]
    v_mfma_f32_16x16x32_bf16 v[176:179], v[140:143], v[32:35], v[176:179]
    ds_read_b64_tr_b16 v[80:81], v148 offset:7680
    ds_read_b64_tr_b16 v[82:83], v148 offset:7840
    s_waitcnt lgkmcnt(14)
    v_mfma_f32_16x16x32_bf16 v[128:131], v[32:35], v[84:87], v[128:131]
    v_mfma_f32_16x16x32_bf16 v[180:183], v[32:35], v[32:35], v[180:183]
    ds_read_b64_tr_b16 v[84:85], v148 offset:7712
    ds_read_b64_tr_b16 v[86:87], v148 offset:7872
    s_waitcnt lgkmcnt(14) vmcnt(6)
    v_mfma_f32_16x16x32_bf16 v[124:127], v[36:39], v[88:91], v[124:127]
    v_mfma_f32_16x16x32_bf16 v[176:179], v[140:143], v[36:39], v[176:179]
    ds_read_b64_tr_b16 v[88:89], v148 offset:8960
    ds_read_b64_tr_b16 v[90:91], v148 offset:9120
    s_waitcnt lgkmcnt(14)
    v_mfma_f32_16x16x32_bf16 v[128:131], v[36:39], v[92:95], v[128:131]
    v_mfma_f32_16x16x32_bf16 v[180:183], v[36:39], v[36:39], v[180:183]
    ds_read_b64_tr_b16 v[92:93], v148 offset:8992
    ds_read_b64_tr_b16 v[94:95], v148 offset:9152
    s_waitcnt lgkmcnt(14) vmcnt(5)
    v_mfma_f32_16x16x32_bf16 v[124:127], v[40:43], v[64:67], v[124:127]
    v_mfma_f32_16x16x32_bf16 v[176:179], v[140:143], v[40:43], v[176:179]
    ds_read_b64_tr_b16 v[64:65], v148 offset:10240
    ds_read_b64_tr_b16 v[66:67], v148 offset:10400
    s_waitcnt lgkmcnt(14)
    v_mfma_f32_16x16x32_bf16 v[128:131], v[40:43], v[68:71], v[128:131]
    v_mfma_f32_16x16x32_bf16 v[180:183], v[40:43], v[40:43], v[180:183]
    ds_read_b64_tr_b16 v[68:69], v148 offset:10272
    ds_read_b64_tr_b16 v[70:71], v148 offset:10432
    s_waitcnt lgkmcnt(14) vmcnt(4)
    v_mfma_f32_16x16x32_bf16 v[124:127], v[44:47], v[72:75], v[124:127]
    v_mfma_f32_16x16x32_bf16 v[176:179], v[140:143], v[44:47], v[176:179]
    ds_read_b64_tr_b16 v[72:73], v148 offset:11520
    ds_read_b64_tr_b16 v[74:75], v148 offset:11680
    s_waitcnt lgkmcnt(14)
    v_mfma_f32_16x16x32_bf16 v[128:131], v[44:47], v[76:79], v[128:131]
    v_mfma_f32_16x16x32_bf16 v[180:183], v[44:47], v[44:47], v[180:183]
    ds_read_b64_tr_b16 v[76:77], v148 offset:11552
    ds_read_b64_tr_b16 v[78:79], v148 offset:11712
    s_waitcnt lgkmcnt(14) vmcnt(3)
    v_mfma_f32_16x16x32_bf16 v[124:127], v[48:51], v[80:83], v[124:127]
    v_mfma_f32_16x16x32_bf16 v[176:179], v[140:143], v[48:51], v[176:179]
    s_waitcnt lgkmcnt(12)
    v_mfma_f32_16x16x32_bf16 v[128:131], v[48:51], v[84:87], v[128:131]
    v_mfma_f32_16x16x32_bf16 v[180:183], v[48:51], v[48:51], v[180:183]
    s_waitcnt lgkmcnt(10) vmcnt(2)
    v_mfma_f32_16x16x32_bf16 v[124:127], v[52:55], v[88:91], v[124:127]
    v_mfma_f32_16x16x32_bf16 v[176:179], v[140:143], v[52:55], v[176:179]
    s_waitcnt lgkmcnt(8)
    v_mfma_f32_16x16x32_bf16 v[128:131], v[52:55], v[92:95], v[128:131]
    v_mfma_f32_16x16x32_bf16 v[180:183], v[52:55], v[52:55], v[180:183]
    s_waitcnt lgkmcnt(6) vmcnt(1)
    v_mfma_f32_16x16x32_bf16 v[124:127], v[56:59], v[64:67], v[124:127]
    v_mfma_f32_16x16x32_bf16 v[176:179], v[140:143], v[56:59], v[176:179]
    s_waitcnt lgkmcnt(4)
    v_mfma_f32_16x16x32_bf16 v[128:131], v[56:59], v[68:71], v[128:131]
    v_mfma_f32_16x16x32_bf16 v[180:183], v[56:59], v[56:59], v[180:183]
    s_waitcnt lgkmcnt(2) vmcnt(0)
    v_mfma_f32_16x16x32_bf16 v[124:127], v[60:63], v[72:75], v[124:127]
    v_mfma_f32_16x16x32_bf16 v[176:179], v[140:143], v[60:63], v[176:179]
    s_waitcnt lgkmcnt(0)
    v_mfma_f32_16x16x32_bf16 v[128:131], v[60:63], v[76:79], v[128:131]
    v_mfma_f32_16x16x32_bf16 v[180:183], v[60:63], v[60:63], v[180:183]
    s_branch interleave_layers__grouped_kv_mqa__mixer_channel_mlp__prompt_kernel_kvd12
interleave_layers__grouped_kv_mqa__mixer_channel_mlp__prompt_kernel_kvv16:
    ds_read_b64_tr_b16 v[64:65], v148 offset:0
    ds_read_b64_tr_b16 v[66:67], v148 offset:160
    ds_read_b64_tr_b16 v[68:69], v148 offset:32
    ds_read_b64_tr_b16 v[70:71], v148 offset:192
    ds_read_b64_tr_b16 v[72:73], v148 offset:1280
    ds_read_b64_tr_b16 v[74:75], v148 offset:1440
    ds_read_b64_tr_b16 v[76:77], v148 offset:1312
    ds_read_b64_tr_b16 v[78:79], v148 offset:1472
    ds_read_b64_tr_b16 v[80:81], v148 offset:2560
    ds_read_b64_tr_b16 v[82:83], v148 offset:2720
    ds_read_b64_tr_b16 v[84:85], v148 offset:2592
    ds_read_b64_tr_b16 v[86:87], v148 offset:2752
    ds_read_b64_tr_b16 v[88:89], v148 offset:3840
    ds_read_b64_tr_b16 v[90:91], v148 offset:4000
    ds_read_b64_tr_b16 v[92:93], v148 offset:3872
    ds_read_b64_tr_b16 v[94:95], v148 offset:4032
    s_waitcnt lgkmcnt(14)
    v_mfma_f32_16x16x32_bf16 v[124:127], v[24:27], v[64:67], 0
    v_mfma_f32_16x16x32_bf16 v[132:135], v[140:143], v[64:67], 0
    v_mfma_f32_16x16x32_bf16 v[176:179], v[140:143], v[24:27], 0
    ds_read_b64_tr_b16 v[64:65], v148 offset:5120
    ds_read_b64_tr_b16 v[66:67], v148 offset:5280
    s_waitcnt lgkmcnt(14)
    v_mfma_f32_16x16x32_bf16 v[128:131], v[24:27], v[68:71], 0
    v_mfma_f32_16x16x32_bf16 v[136:139], v[140:143], v[68:71], 0
    v_mfma_f32_16x16x32_bf16 v[180:183], v[24:27], v[24:27], 0
    ds_read_b64_tr_b16 v[68:69], v148 offset:5152
    ds_read_b64_tr_b16 v[70:71], v148 offset:5312
    s_waitcnt lgkmcnt(14)
    v_mfma_f32_16x16x32_bf16 v[124:127], v[28:31], v[72:75], v[124:127]
    v_mfma_f32_16x16x32_bf16 v[132:135], v[140:143], v[72:75], v[132:135]
    v_mfma_f32_16x16x32_bf16 v[176:179], v[140:143], v[28:31], v[176:179]
    ds_read_b64_tr_b16 v[72:73], v148 offset:6400
    ds_read_b64_tr_b16 v[74:75], v148 offset:6560
    s_waitcnt lgkmcnt(14)
    v_mfma_f32_16x16x32_bf16 v[128:131], v[28:31], v[76:79], v[128:131]
    v_mfma_f32_16x16x32_bf16 v[136:139], v[140:143], v[76:79], v[136:139]
    v_mfma_f32_16x16x32_bf16 v[180:183], v[28:31], v[28:31], v[180:183]
    ds_read_b64_tr_b16 v[76:77], v148 offset:6432
    ds_read_b64_tr_b16 v[78:79], v148 offset:6592
    s_waitcnt lgkmcnt(14)
    v_mfma_f32_16x16x32_bf16 v[124:127], v[32:35], v[80:83], v[124:127]
    v_mfma_f32_16x16x32_bf16 v[132:135], v[140:143], v[80:83], v[132:135]
    v_mfma_f32_16x16x32_bf16 v[176:179], v[140:143], v[32:35], v[176:179]
    ds_read_b64_tr_b16 v[80:81], v148 offset:7680
    ds_read_b64_tr_b16 v[82:83], v148 offset:7840
    s_waitcnt lgkmcnt(14)
    v_mfma_f32_16x16x32_bf16 v[128:131], v[32:35], v[84:87], v[128:131]
    v_mfma_f32_16x16x32_bf16 v[136:139], v[140:143], v[84:87], v[136:139]
    v_mfma_f32_16x16x32_bf16 v[180:183], v[32:35], v[32:35], v[180:183]
    ds_read_b64_tr_b16 v[84:85], v148 offset:7712
    ds_read_b64_tr_b16 v[86:87], v148 offset:7872
    s_waitcnt lgkmcnt(14)
    v_mfma_f32_16x16x32_bf16 v[124:127], v[36:39], v[88:91], v[124:127]
    v_mfma_f32_16x16x32_bf16 v[132:135], v[140:143], v[88:91], v[132:135]
    v_mfma_f32_16x16x32_bf16 v[176:179], v[140:143], v[36:39], v[176:179]
    ds_read_b64_tr_b16 v[88:89], v148 offset:8960
    ds_read_b64_tr_b16 v[90:91], v148 offset:9120
    s_waitcnt lgkmcnt(14)
    v_mfma_f32_16x16x32_bf16 v[128:131], v[36:39], v[92:95], v[128:131]
    v_mfma_f32_16x16x32_bf16 v[136:139], v[140:143], v[92:95], v[136:139]
    v_mfma_f32_16x16x32_bf16 v[180:183], v[36:39], v[36:39], v[180:183]
    ds_read_b64_tr_b16 v[92:93], v148 offset:8992
    ds_read_b64_tr_b16 v[94:95], v148 offset:9152
    s_waitcnt lgkmcnt(14)
    v_mfma_f32_16x16x32_bf16 v[124:127], v[40:43], v[64:67], v[124:127]
    v_mfma_f32_16x16x32_bf16 v[132:135], v[140:143], v[64:67], v[132:135]
    v_mfma_f32_16x16x32_bf16 v[176:179], v[140:143], v[40:43], v[176:179]
    ds_read_b64_tr_b16 v[64:65], v148 offset:10240
    ds_read_b64_tr_b16 v[66:67], v148 offset:10400
    s_waitcnt lgkmcnt(14)
    v_mfma_f32_16x16x32_bf16 v[128:131], v[40:43], v[68:71], v[128:131]
    v_mfma_f32_16x16x32_bf16 v[136:139], v[140:143], v[68:71], v[136:139]
    v_mfma_f32_16x16x32_bf16 v[180:183], v[40:43], v[40:43], v[180:183]
    ds_read_b64_tr_b16 v[68:69], v148 offset:10272
    ds_read_b64_tr_b16 v[70:71], v148 offset:10432
    s_waitcnt lgkmcnt(14)
    v_mfma_f32_16x16x32_bf16 v[124:127], v[44:47], v[72:75], v[124:127]
    v_mfma_f32_16x16x32_bf16 v[132:135], v[140:143], v[72:75], v[132:135]
    v_mfma_f32_16x16x32_bf16 v[176:179], v[140:143], v[44:47], v[176:179]
    ds_read_b64_tr_b16 v[72:73], v148 offset:11520
    ds_read_b64_tr_b16 v[74:75], v148 offset:11680
    s_waitcnt lgkmcnt(14)
    v_mfma_f32_16x16x32_bf16 v[128:131], v[44:47], v[76:79], v[128:131]
    v_mfma_f32_16x16x32_bf16 v[136:139], v[140:143], v[76:79], v[136:139]
    v_mfma_f32_16x16x32_bf16 v[180:183], v[44:47], v[44:47], v[180:183]
    ds_read_b64_tr_b16 v[76:77], v148 offset:11552
    ds_read_b64_tr_b16 v[78:79], v148 offset:11712
    s_waitcnt lgkmcnt(14)
    v_mfma_f32_16x16x32_bf16 v[124:127], v[48:51], v[80:83], v[124:127]
    v_mfma_f32_16x16x32_bf16 v[132:135], v[140:143], v[80:83], v[132:135]
    v_mfma_f32_16x16x32_bf16 v[176:179], v[140:143], v[48:51], v[176:179]
    s_waitcnt lgkmcnt(12)
    v_mfma_f32_16x16x32_bf16 v[128:131], v[48:51], v[84:87], v[128:131]
    v_mfma_f32_16x16x32_bf16 v[136:139], v[140:143], v[84:87], v[136:139]
    v_mfma_f32_16x16x32_bf16 v[180:183], v[48:51], v[48:51], v[180:183]
    s_waitcnt lgkmcnt(10)
    v_mfma_f32_16x16x32_bf16 v[124:127], v[52:55], v[88:91], v[124:127]
    v_mfma_f32_16x16x32_bf16 v[132:135], v[140:143], v[88:91], v[132:135]
    v_mfma_f32_16x16x32_bf16 v[176:179], v[140:143], v[52:55], v[176:179]
    s_waitcnt lgkmcnt(8)
    v_mfma_f32_16x16x32_bf16 v[128:131], v[52:55], v[92:95], v[128:131]
    v_mfma_f32_16x16x32_bf16 v[136:139], v[140:143], v[92:95], v[136:139]
    v_mfma_f32_16x16x32_bf16 v[180:183], v[52:55], v[52:55], v[180:183]
    s_waitcnt lgkmcnt(6)
    v_mfma_f32_16x16x32_bf16 v[124:127], v[56:59], v[64:67], v[124:127]
    v_mfma_f32_16x16x32_bf16 v[132:135], v[140:143], v[64:67], v[132:135]
    v_mfma_f32_16x16x32_bf16 v[176:179], v[140:143], v[56:59], v[176:179]
    s_waitcnt lgkmcnt(4)
    v_mfma_f32_16x16x32_bf16 v[128:131], v[56:59], v[68:71], v[128:131]
    v_mfma_f32_16x16x32_bf16 v[136:139], v[140:143], v[68:71], v[136:139]
    v_mfma_f32_16x16x32_bf16 v[180:183], v[56:59], v[56:59], v[180:183]
    s_waitcnt lgkmcnt(2)
    v_mfma_f32_16x16x32_bf16 v[124:127], v[60:63], v[72:75], v[124:127]
    v_mfma_f32_16x16x32_bf16 v[132:135], v[140:143], v[72:75], v[132:135]
    v_mfma_f32_16x16x32_bf16 v[176:179], v[140:143], v[60:63], v[176:179]
    s_waitcnt lgkmcnt(0)
    v_mfma_f32_16x16x32_bf16 v[128:131], v[60:63], v[76:79], v[128:131]
    v_mfma_f32_16x16x32_bf16 v[136:139], v[140:143], v[76:79], v[136:139]
    v_mfma_f32_16x16x32_bf16 v[180:183], v[60:63], v[60:63], v[180:183]
    s_branch interleave_layers__grouped_kv_mqa__mixer_channel_mlp__prompt_kernel_kvd12
interleave_layers__grouped_kv_mqa__mixer_channel_mlp__prompt_kernel_kvd12:
    s_cmp_lg_u32 s12, 0
    s_cbranch_scc1 interleave_layers__grouped_kv_mqa__mixer_channel_mlp__prompt_kernel_nz17
    s_mov_b32 s30, 0
interleave_layers__grouped_kv_mqa__mixer_channel_mlp__prompt_kernel_npl18:
    s_waitcnt vmcnt(0)
    v_cmp_eq_u32 vcc, 0, v201
    s_cbranch_vccz interleave_layers__grouped_kv_mqa__mixer_channel_mlp__prompt_kernel_npd19
    v_mov_b32 v200, 0
    buffer_load_dword v201, v200, s[60:63], 0 offen sc1
    s_add_u32 s30, s30, 1
    s_cmp_lt_u32 s30, 0x40000
    s_cbranch_scc1 interleave_layers__grouped_kv_mqa__mixer_channel_mlp__prompt_kernel_npl18
    s_waitcnt vmcnt(0)
interleave_layers__grouped_kv_mqa__mixer_channel_mlp__prompt_kernel_npd19:
    v_readfirstlane_b32 s13, v201
    v_mov_b32 v200, 163776
    ds_write_b32 v200, v201
interleave_layers__grouped_kv_mqa__mixer_channel_mlp__prompt_kernel_nz17:
    v_and_b32 v150, 3, v1
    s_nop 3
    v_mov_b32 v147, v180
    v_cmp_eq_u32 vcc, 1, v150
    s_nop 1
    v_cndmask_b32 v147, v147, v181, vcc
    v_cmp_eq_u32 vcc, 2, v150
    s_nop 1
    v_cndmask_b32 v147, v147, v182, vcc
    v_cmp_eq_u32 vcc, 3, v150
    s_nop 1
    v_cndmask_b32 v147, v147, v183, vcc
    v_mov_b32 v146, v176
    s_lshl_b32 s28, s4, 8
    s_lshl_b32 s29, s5, 7
    s_add_u32 s28, s28, s29
    s_add_u32 s28, s28, 152576
    v_lshl_add_u32 v150, v2, 3, s28
    s_mov_b32 exec_lo, 0x00f0000f
    s_mov_b32 exec_hi, 0xf0000f00
    ds_write_b64 v150, v[146:147]
    s_mov_b64 exec, -1
    v_add_u32 v149, 157056, v4
    s_cmp_eq_u32 s5, 1
    s_cbranch_scc1 interleave_layers__grouped_kv_mqa__mixer_channel_mlp__prompt_kernel_ka20
    ds_write_b128 v149, v[128:131] offset:2048
    ds_write_b128 v149, v[136:139] offset:3072
    s_branch interleave_layers__grouped_kv_mqa__mixer_channel_mlp__prompt_kernel_kb21
interleave_layers__grouped_kv_mqa__mixer_channel_mlp__prompt_kernel_ka20:
    ds_write_b128 v149, v[124:127]
    ds_write_b128 v149, v[132:135] offset:1024
    v_mov_b32 v124, v128
    v_mov_b32 v132, v136
    v_mov_b32 v125, v129
    v_mov_b32 v133, v137
    v_mov_b32 v126, v130
    v_mov_b32 v134, v138
    v_mov_b32 v127, v131
    v_mov_b32 v135, v139
interleave_layers__grouped_kv_mqa__mixer_channel_mlp__prompt_kernel_kb21:
    s_add_u32 s28, s13, 1
    v_mov_b32 v150, s28
    s_lshl_b32 s29, s5, 2
    s_add_u32 s29, s29, 163784
    v_mov_b32 v151, s29
    s_waitcnt lgkmcnt(0)
    ds_write_b32 v151, v150
    v_xor_b32 v151, 4, v151
    s_mov_b32 s30, 0
interleave_layers__grouped_kv_mqa__mixer_channel_mlp__prompt_kernel_pr22:
    ds_read_b32 v152, v151
    s_waitcnt lgkmcnt(0)
    v_cmp_eq_u32 vcc, s28, v152
    s_cbranch_vccnz interleave_layers__grouped_kv_mqa__mixer_channel_mlp__prompt_kernel_prd23
    s_add_u32 s30, s30, 1
    s_cmp_lt_u32 s30, 0x100000
    s_cbranch_scc1 interleave_layers__grouped_kv_mqa__mixer_channel_mlp__prompt_kernel_pr22
interleave_layers__grouped_kv_mqa__mixer_channel_mlp__prompt_kernel_prd23:
    s_lshl_b32 s28, s5, 11
    s_add_u32 s28, s28, 157056
    v_add_u32 v149, s28, v4
    ds_read_b128 v[64:67], v149
    ds_read_b128 v[68:71], v149 offset:1024
    s_lshl_b32 s28, s4, 8
    s_add_u32 s28, s28, 152576
    v_lshl_add_u32 v150, v2, 3, s28
    ds_read_b64 v[154:155], v150
    ds_read_b64 v[156:157], v150 offset:128
    s_lshl_b32 s28, s5, 10
    s_add_u32 s28, s28, 155008
    v_add_u32 v151, s28, v4
    s_cmp_eq_u32 s12, 0
    s_cbranch_scc1 interleave_layers__grouped_kv_mqa__mixer_channel_mlp__prompt_kernel_c024
    ds_read_b128 v[132:135], v151
    s_waitcnt lgkmcnt(0)
    s_branch interleave_layers__grouped_kv_mqa__mixer_channel_mlp__prompt_kernel_c125
interleave_layers__grouped_kv_mqa__mixer_channel_mlp__prompt_kernel_c024:
    s_waitcnt lgkmcnt(0)
    v_add_f32 v132, v132, v68
    v_add_f32 v133, v133, v69
    v_add_f32 v134, v134, v70
    v_add_f32 v135, v135, v71
    ds_write_b128 v151, v[132:135]
interleave_layers__grouped_kv_mqa__mixer_channel_mlp__prompt_kernel_c125:
    v_add_f32 v124, v124, v64
    v_add_f32 v125, v125, v65
    v_add_f32 v126, v126, v66
    v_add_f32 v127, v127, v67
    v_add_f32 v154, v154, v156
    v_add_f32 v155, v155, v157
    v_mul_f32 v158, 0x3acccccd, v154
    v_mul_f32 v155, 0x3acccccd, v155
    v_fma_f32 v155, -v158, v158, v155
    v_max_f32 v155, 0, v155
    v_add_f32 v155, 0x3727c5ac, v155
    v_rsq_f32 v159, v155
    s_nop 0
    v_mul_f32 v158, v158, v159
    s_lshl_b32 s30, s6, 6
    s_lshl_b32 s31, s4, 4
    s_add_u32 s30, s30, s31
    s_lshr_b32 s31, s30, 5
    s_mul_i32 s31, s31, 3584
    s_mul_i32 s32, s12, 229376
    s_add_u32 s31, s31, s32
    s_add_u32 s31, s31, 32768
    s_lshr_b32 s32, s30, 4
    s_and_b32 s32, s32, 1
    s_and_b32 s28, s7, 1
    s_cmp_eq_u32 s28, 1
    s_cbranch_scc1 interleave_layers__grouped_kv_mqa__mixer_channel_mlp__prompt_kernel_isv226
    v_mul_f32 v124, v124, v159
    v_fma_f32 v124, -v158, v132, v124
    v_mul_f32 v125, v125, v159
    v_fma_f32 v125, -v158, v133, v125
    v_mul_f32 v126, v126, v159
    v_fma_f32 v126, -v158, v134, v126
    v_mul_f32 v127, v127, v159
    v_fma_f32 v127, -v158, v135, v127
    s_lshl_b32 s28, s5, 2
    v_add_u32 v150, s28, v3
    v_cmp_eq_u32 vcc, 5, v150
    s_nop 1
    v_cndmask_b32 v124, v124, 0, vcc
    v_cndmask_b32 v125, v125, 0, vcc
    v_cndmask_b32 v126, v126, 0, vcc
    v_cndmask_b32 v127, v127, 0, vcc
    v_cvt_pk_bf16_f32 v124, v124, v125
    v_cvt_pk_bf16_f32 v125, v126, v127
    s_lshl_b32 s28, s32, 4
    v_add_u32 v151, s28, v2
    v_lshrrev_b32 v152, 1, v150
    v_lshlrev_b32 v152, 9, v152
    v_lshl_add_u32 v152, v151, 4, v152
    v_and_b32 v153, 1, v150
    v_lshl_add_u32 v152, v153, 3, v152
    v_subrev_u32 v153, 4, v150
    v_lshlrev_b32 v153, 8, v153
    v_lshl_add_u32 v153, v151, 3, v153
    v_add_u32 v153, 3072, v153
    v_cmp_gt_u32 vcc, 4, v150
    s_nop 1
    v_cndmask_b32 v152, v153, v152, vcc
    v_cmp_gt_u32 vcc, 6, v150
    v_mov_b32 v153, 0x40000000
    s_nop 0
    v_cndmask_b32 v152, v153, v152, vcc
    buffer_store_dwordx2 v[124:125], v152, s[8:11], s31 offen sc1
    s_branch interleave_layers__grouped_kv_mqa__mixer_channel_mlp__prompt_kernel_nokv11
interleave_layers__grouped_kv_mqa__mixer_channel_mlp__prompt_kernel_isv226:
    s_lshl_b32 s28, s4, 8
    s_add_u32 s28, s28, 152576
    v_lshl_add_u32 v150, v3, 5, s28
    ds_read_b128 v[72:75], v150
    ds_read_b128 v[76:79], v150 offset:16
    ds_read_b128 v[80:83], v150 offset:128
    ds_read_b128 v[84:87], v150 offset:144
    s_waitcnt lgkmcnt(0)
    v_add_f32 v72, v72, v80
    v_add_f32 v73, v73, v81
    v_mul_f32 v72, 0x3acccccd, v72
    v_mul_f32 v73, 0x3acccccd, v73
    v_fma_f32 v73, -v72, v72, v73
    v_max_f32 v73, 0, v73
    v_add_f32 v73, 0x3727c5ac, v73
    v_rsq_f32 v73, v73
    v_fma_f32 v124, -v72, v132, v124
    v_mul_f32 v124, v124, v73
    v_add_f32 v74, v74, v82
    v_add_f32 v75, v75, v83
    v_mul_f32 v74, 0x3acccccd, v74
    v_mul_f32 v75, 0x3acccccd, v75
    v_fma_f32 v75, -v74, v74, v75
    v_max_f32 v75, 0, v75
    v_add_f32 v75, 0x3727c5ac, v75
    v_rsq_f32 v75, v75
    v_fma_f32 v125, -v74, v133, v125
    v_mul_f32 v125, v125, v75
    v_add_f32 v76, v76, v84
    v_add_f32 v77, v77, v85
    v_mul_f32 v76, 0x3acccccd, v76
    v_mul_f32 v77, 0x3acccccd, v77
    v_fma_f32 v77, -v76, v76, v77
    v_max_f32 v77, 0, v77
    v_add_f32 v77, 0x3727c5ac, v77
    v_rsq_f32 v77, v77
    v_fma_f32 v126, -v76, v134, v126
    v_mul_f32 v126, v126, v77
    v_add_f32 v78, v78, v86
    v_add_f32 v79, v79, v87
    v_mul_f32 v78, 0x3acccccd, v78
    v_mul_f32 v79, 0x3acccccd, v79
    v_fma_f32 v79, -v78, v78, v79
    v_max_f32 v79, 0, v79
    v_add_f32 v79, 0x3727c5ac, v79
    v_rsq_f32 v79, v79
    v_fma_f32 v127, -v78, v135, v127
    v_mul_f32 v127, v127, v79
    s_lshl_b32 s28, s5, 4
    v_add_u32 v150, s28, v2
    v_cmp_eq_u32 vcc, 20, v150
    s_nop 1
    v_cndmask_b32 v124, v124, 1.0, vcc
    v_cndmask_b32 v125, v125, 1.0, vcc
    v_cndmask_b32 v126, v126, 1.0, vcc
    v_cndmask_b32 v127, v127, 1.0, vcc
    v_cmp_lt_u32 vcc, 20, v150
    s_nop 1
    v_cndmask_b32 v124, v124, 0, vcc
    v_cndmask_b32 v125, v125, 0, vcc
    v_cndmask_b32 v126, v126, 0, vcc
    v_cndmask_b32 v127, v127, 0, vcc
    v_cvt_pk_bf16_f32 v124, v124, v125
    v_cvt_pk_bf16_f32 v125, v126, v127
    s_lshl_b32 s28, s32, 10
    s_add_u32 s28, s28, 1024
    v_and_b32 v151, 1, v3
    v_lshlrev_b32 v151, 9, v151
    v_lshl_add_u32 v151, v150, 4, v151
    v_lshrrev_b32 v152, 1, v3
    v_lshl_add_u32 v151, v152, 3, v151
    v_add_u32 v151, s28, v151
    buffer_store_dwordx2 v[124:125], v151, s[8:11], s31 offen sc1
interleave_layers__grouped_kv_mqa__mixer_channel_mlp__prompt_kernel_nokv11:
    s_cmp_lg_u32 s12, 0
    s_cbranch_scc1 interleave_layers__grouped_kv_mqa__mixer_channel_mlp__prompt_kernel_l227
    s_waitcnt vmcnt(0)
    s_lshr_b32 s28, s7, 1
    s_cmp_lg_u32 s28, s4
    s_cbranch_scc1 interleave_layers__grouped_kv_mqa__mixer_channel_mlp__prompt_kernel_nkf28
    s_waitcnt vmcnt(0)
    s_add_u32 s28, s13, 1
    v_mov_b32 v149, s28
    s_lshl_b32 s29, s6, 6
    s_lshl_b32 s30, s7, 3
    s_add_u32 s29, s29, s30
    s_lshl_b32 s30, s5, 2
    s_add_u32 s29, s29, s30
    s_add_u32 s29, s29, 16384
    v_mov_b32 v150, s29
    s_mov_b64 exec, 1
    buffer_store_dword v149, v150, s[8:11], 0 offen sc1
    s_mov_b64 exec, -1
interleave_layers__grouped_kv_mqa__mixer_channel_mlp__prompt_kernel_nkf28:
    s_waitcnt lgkmcnt(0)
    s_barrier
    v_mov_b32 v200, 163776
    ds_read_b32 v201, v200
    s_waitcnt lgkmcnt(0)
    v_readfirstlane_b32 s13, v201
    s_mov_b32 s50, 0
    s_lshl_b32 s28, s43, 8
    s_add_u32 s28, s28, s2
    s_cmp_ge_u32 s28, 1480
    s_cbranch_scc1 interleave_layers__grouped_kv_mqa__mixer_channel_mlp__prompt_kernel_cvd29
    s_cmp_lt_u32 s28, 200
    s_cbranch_scc1 interleave_layers__grouped_kv_mqa__mixer_channel_mlp__prompt_kernel_cvk31
    s_cmp_lt_u32 s28, 400
    s_cbranch_scc1 interleave_layers__grouped_kv_mqa__mixer_channel_mlp__prompt_kernel_cvk32
    s_cmp_lt_u32 s28, 940
    s_cbranch_scc1 interleave_layers__grouped_kv_mqa__mixer_channel_mlp__prompt_kernel_cvk33
    s_branch interleave_layers__grouped_kv_mqa__mixer_channel_mlp__prompt_kernel_cvk34
interleave_layers__grouped_kv_mqa__mixer_channel_mlp__prompt_kernel_cvk31:
    s_mul_i32 s29, s28, 6554
    s_lshr_b32 s29, s29, 16
    s_mul_i32 s30, s29, 10
    s_sub_u32 s30, s28, s30
    s_mov_b32 s16, s72
    s_mov_b32 s17, s73
    s_and_b32 s17, s17, 0xffff
    s_mov_b32 s18, 819200
    s_mov_b32 s19, 0x20000
    s_movk_i32 s31, 1280
    s_mov_b32 s50, 2
    s_mul_i32 s51, s30, 80
    s_add_u32 s51, s51, s29
    s_mov_b32 s57, 20480
    s_lshl_b32 s51, s51, 10
    s_add_u32 s51, s51, 32702464
    s_branch interleave_layers__grouped_kv_mqa__mixer_channel_mlp__prompt_kernel_cvg30
interleave_layers__grouped_kv_mqa__mixer_channel_mlp__prompt_kernel_cvk32:
    s_sub_u32 s28, s28, 200
    s_mul_i32 s29, s28, 6554
    s_lshr_b32 s29, s29, 16
    s_mul_i32 s30, s29, 10
    s_sub_u32 s30, s28, s30
    s_mov_b32 s16, s66
    s_mov_b32 s17, s67
    s_and_b32 s17, s17, 0xffff
    s_mov_b32 s18, 819200
    s_mov_b32 s19, 0x20000
    s_movk_i32 s31, 1280
    s_mov_b32 s50, 2
    s_mul_i32 s51, s30, 80
    s_add_u32 s51, s51, s29
    s_mov_b32 s57, 20480
    s_lshl_b32 s51, s51, 10
    s_add_u32 s51, s51, 33521664
    s_branch interleave_layers__grouped_kv_mqa__mixer_channel_mlp__prompt_kernel_cvg30
interleave_layers__grouped_kv_mqa__mixer_channel_mlp__prompt_kernel_cvk33:
    s_sub_u32 s28, s28, 400
    s_mul_i32 s29, s28, 2428
    s_lshr_b32 s29, s29, 16
    s_mul_i32 s30, s29, 27
    s_sub_u32 s30, s28, s30
    s_mov_b32 s16, s76
    s_mov_b32 s17, s77
    s_and_b32 s17, s17, 0xffff
    s_mov_b32 s18, 2211840
    s_mov_b32 s19, 0x20000
    s_movk_i32 s31, 3456
    s_mov_b32 s50, 1
    s_mul_i32 s51, s30, 80
    s_lshl_b32 s32, s29, 1
    s_add_u32 s51, s51, s32
    s_mov_b32 s57, 0
    s_lshl_b32 s51, s51, 10
    s_add_u32 s51, s51, 28278784
    s_branch interleave_layers__grouped_kv_mqa__mixer_channel_mlp__prompt_kernel_cvg30
interleave_layers__grouped_kv_mqa__mixer_channel_mlp__prompt_kernel_cvk34:
    s_sub_u32 s28, s28, 940
    s_mul_i32 s29, s28, 6554
    s_lshr_b32 s29, s29, 16
    s_mul_i32 s30, s29, 10
    s_sub_u32 s30, s28, s30
    s_mov_b32 s16, s80
    s_mov_b32 s17, s81
    s_and_b32 s17, s17, 0xffff
    s_mov_b32 s18, 2211840
    s_mov_b32 s19, 0x20000
    s_movk_i32 s31, 1280
    s_mov_b32 s50, 2
    s_mul_i32 s51, s30, 216
    s_add_u32 s51, s51, s29
    s_mov_b32 s57, 55296
    s_lshl_b32 s51, s51, 10
    s_add_u32 s51, s51, 30490624
    s_branch interleave_layers__grouped_kv_mqa__mixer_channel_mlp__prompt_kernel_cvg30
interleave_layers__grouped_kv_mqa__mixer_channel_mlp__prompt_kernel_cvg30:
    v_lshrrev_b32 v200, 3, v1
    v_mul_lo_u32 v200, v200, s31
    v_and_b32 v201, 7, v1
    v_lshl_add_u32 v200, v201, 4, v200
    s_lshl_b32 s32, s29, 5
    s_mul_i32 s32, s32, s31
    s_lshl_b32 s33, s30, 7
    s_add_u32 s32, s32, s33
    s_lshl_b32 s33, s31, 3
    s_lshl_b32 s34, s43, 12
    s_add_u32 s34, s34, 128000
    s_mov_b32 m0, s34
    s_nop 0
    buffer_load_dwordx4 v200, s[16:19], s32 offen lds
    s_add_u32 s32, s32, s33
    s_add_u32 s34, s34, 1024
    s_mov_b32 m0, s34
    s_nop 0
    buffer_load_dwordx4 v200, s[16:19], s32 offen lds
    s_add_u32 s32, s32, s33
    s_add_u32 s34, s34, 1024
    s_mov_b32 m0, s34
    s_nop 0
    buffer_load_dwordx4 v200, s[16:19], s32 offen lds
    s_add_u32 s32, s32, s33
    s_add_u32 s34, s34, 1024
    s_mov_b32 m0, s34
    s_nop 0
    buffer_load_dwordx4 v200, s[16:19], s32 offen lds
interleave_layers__grouped_kv_mqa__mixer_channel_mlp__prompt_kernel_cvd29:
interleave_layers__grouped_kv_mqa__mixer_channel_mlp__prompt_kernel_l227:
    s_mul_i32 s28, s5, 51200
    v_add_u32 v144, s28, v7
    s_lshl_b32 s29, s4, 5
    v_add_u32 v145, s29, v144
    s_cmp_eq_u32 s12, 0
    s_cbranch_scc0 interleave_layers__grouped_kv_mqa__mixer_channel_mlp__prompt_kernel_m135
    ds_read_b64_tr_b16 v[64:65], v144 offset:0
    ds_read_b64_tr_b16 v[66:67], v144 offset:1280
    ds_read_b64_tr_b16 v[68:69], v144 offset:32
    ds_read_b64_tr_b16 v[70:71], v144 offset:1312
    ds_read_b64_tr_b16 v[72:73], v144 offset:64
    ds_read_b64_tr_b16 v[74:75], v144 offset:1344
    ds_read_b64_tr_b16 v[76:77], v144 offset:96
    ds_read_b64_tr_b16 v[78:79], v144 offset:1376
    ds_read_b64_tr_b16 v[80:81], v144 offset:128
    ds_read_b64_tr_b16 v[82:83], v144 offset:1408
    ds_read_b64_tr_b16 v[84:85], v145 offset:0
    ds_read_b64_tr_b16 v[86:87], v145 offset:1280
    ds_read_b64_tr_b16 v[88:89], v144 offset:5120
    ds_read_b64_tr_b16 v[90:91], v144 offset:6400
    ds_read_b64_tr_b16 v[92:93], v144 offset:5152
    ds_read_b64_tr_b16 v[94:95], v144 offset:6432
    s_waitcnt lgkmcnt(14)
    v_mfma_f32_16x16x32_bf16 v[96:99], v[64:67], v[24:27], 0
    v_mfma_f32_16x16x32_bf16 v[176:179], v[140:143], v[24:27], 0
    ds_read_b64_tr_b16 v[64:65], v144 offset:5184
    ds_read_b64_tr_b16 v[66:67], v144 offset:6464
    s_waitcnt lgkmcnt(14)
    v_mfma_f32_16x16x32_bf16 v[100:103], v[68:71], v[24:27], 0
    ds_read_b64_tr_b16 v[68:69], v144 offset:5216
    ds_read_b64_tr_b16 v[70:71], v144 offset:6496
    s_waitcnt lgkmcnt(14)
    v_mfma_f32_16x16x32_bf16 v[104:107], v[72:75], v[24:27], 0
    v_mfma_f32_16x16x32_bf16 v[180:183], v[24:27], v[24:27], 0
    ds_read_b64_tr_b16 v[72:73], v144 offset:5248
    ds_read_b64_tr_b16 v[74:75], v144 offset:6528
    s_waitcnt lgkmcnt(14)
    v_mfma_f32_16x16x32_bf16 v[108:111], v[76:79], v[24:27], 0
    ds_read_b64_tr_b16 v[76:77], v145 offset:5120
    ds_read_b64_tr_b16 v[78:79], v145 offset:6400
    s_waitcnt lgkmcnt(14)
    v_mfma_f32_16x16x32_bf16 v[112:115], v[80:83], v[24:27], 0
    v_mfma_f32_16x16x32_bf16 v[120:123], v[80:83], v[140:143], 0
    ds_read_b64_tr_b16 v[80:81], v144 offset:10240
    ds_read_b64_tr_b16 v[82:83], v144 offset:11520
    s_waitcnt lgkmcnt(14)
    v_mfma_f32_16x16x32_bf16 v[116:119], v[84:87], v[140:143], 0
    ds_read_b64_tr_b16 v[84:85], v144 offset:10272
    ds_read_b64_tr_b16 v[86:87], v144 offset:11552
    s_waitcnt lgkmcnt(14)
    v_mfma_f32_16x16x32_bf16 v[96:99], v[88:91], v[28:31], v[96:99]
    v_mfma_f32_16x16x32_bf16 v[176:179], v[140:143], v[28:31], v[176:179]
    ds_read_b64_tr_b16 v[88:89], v144 offset:10304
    ds_read_b64_tr_b16 v[90:91], v144 offset:11584
    s_waitcnt lgkmcnt(14)
    v_mfma_f32_16x16x32_bf16 v[100:103], v[92:95], v[28:31], v[100:103]
    ds_read_b64_tr_b16 v[92:93], v144 offset:10336
    ds_read_b64_tr_b16 v[94:95], v144 offset:11616
    s_waitcnt lgkmcnt(14)
    v_mfma_f32_16x16x32_bf16 v[104:107], v[64:67], v[28:31], v[104:107]
    v_mfma_f32_16x16x32_bf16 v[180:183], v[28:31], v[28:31], v[180:183]
    ds_read_b64_tr_b16 v[64:65], v144 offset:10368
    ds_read_b64_tr_b16 v[66:67], v144 offset:11648
    s_waitcnt lgkmcnt(14)
    v_mfma_f32_16x16x32_bf16 v[108:111], v[68:71], v[28:31], v[108:111]
    ds_read_b64_tr_b16 v[68:69], v145 offset:10240
    ds_read_b64_tr_b16 v[70:71], v145 offset:11520
    s_waitcnt lgkmcnt(14)
    v_mfma_f32_16x16x32_bf16 v[112:115], v[72:75], v[28:31], v[112:115]
    v_mfma_f32_16x16x32_bf16 v[120:123], v[72:75], v[140:143], v[120:123]
    ds_read_b64_tr_b16 v[72:73], v144 offset:15360
    ds_read_b64_tr_b16 v[74:75], v144 offset:16640
    s_waitcnt lgkmcnt(14)
    v_mfma_f32_16x16x32_bf16 v[116:119], v[76:79], v[140:143], v[116:119]
    ds_read_b64_tr_b16 v[76:77], v144 offset:15392
    ds_read_b64_tr_b16 v[78:79], v144 offset:16672
    s_waitcnt lgkmcnt(14)
    v_mfma_f32_16x16x32_bf16 v[96:99], v[80:83], v[32:35], v[96:99]
    v_mfma_f32_16x16x32_bf16 v[176:179], v[140:143], v[32:35], v[176:179]
    ds_read_b64_tr_b16 v[80:81], v144 offset:15424
    ds_read_b64_tr_b16 v[82:83], v144 offset:16704
    s_waitcnt lgkmcnt(14)
    v_mfma_f32_16x16x32_bf16 v[100:103], v[84:87], v[32:35], v[100:103]
    ds_read_b64_tr_b16 v[84:85], v144 offset:15456
    ds_read_b64_tr_b16 v[86:87], v144 offset:16736
    s_waitcnt lgkmcnt(14)
    v_mfma_f32_16x16x32_bf16 v[104:107], v[88:91], v[32:35], v[104:107]
    v_mfma_f32_16x16x32_bf16 v[180:183], v[32:35], v[32:35], v[180:183]
    ds_read_b64_tr_b16 v[88:89], v144 offset:15488
    ds_read_b64_tr_b16 v[90:91], v144 offset:16768
    s_waitcnt lgkmcnt(14)
    v_mfma_f32_16x16x32_bf16 v[108:111], v[92:95], v[32:35], v[108:111]
    ds_read_b64_tr_b16 v[92:93], v145 offset:15360
    ds_read_b64_tr_b16 v[94:95], v145 offset:16640
    s_waitcnt lgkmcnt(14)
    v_mfma_f32_16x16x32_bf16 v[112:115], v[64:67], v[32:35], v[112:115]
    v_mfma_f32_16x16x32_bf16 v[120:123], v[64:67], v[140:143], v[120:123]
    ds_read_b64_tr_b16 v[64:65], v144 offset:20480
    ds_read_b64_tr_b16 v[66:67], v144 offset:21760
    s_waitcnt lgkmcnt(14)
    v_mfma_f32_16x16x32_bf16 v[116:119], v[68:71], v[140:143], v[116:119]
    ds_read_b64_tr_b16 v[68:69], v144 offset:20512
    ds_read_b64_tr_b16 v[70:71], v144 offset:21792
    s_waitcnt lgkmcnt(14)
    v_mfma_f32_16x16x32_bf16 v[96:99], v[72:75], v[36:39], v[96:99]
    v_mfma_f32_16x16x32_bf16 v[176:179], v[140:143], v[36:39], v[176:179]
    ds_read_b64_tr_b16 v[72:73], v144 offset:20544
    ds_read_b64_tr_b16 v[74:75], v144 offset:21824
    s_waitcnt lgkmcnt(14)
    v_mfma_f32_16x16x32_bf16 v[100:103], v[76:79], v[36:39], v[100:103]
    ds_read_b64_tr_b16 v[76:77], v144 offset:20576
    ds_read_b64_tr_b16 v[78:79], v144 offset:21856
    s_waitcnt lgkmcnt(14)
    v_mfma_f32_16x16x32_bf16 v[104:107], v[80:83], v[36:39], v[104:107]
    v_mfma_f32_16x16x32_bf16 v[180:183], v[36:39], v[36:39], v[180:183]
    ds_read_b64_tr_b16 v[80:81], v144 offset:20608
    ds_read_b64_tr_b16 v[82:83], v144 offset:21888
    s_waitcnt lgkmcnt(14)
    v_mfma_f32_16x16x32_bf16 v[108:111], v[84:87], v[36:39], v[108:111]
    ds_read_b64_tr_b16 v[84:85], v145 offset:20480
    ds_read_b64_tr_b16 v[86:87], v145 offset:21760
    s_waitcnt lgkmcnt(14)
    v_mfma_f32_16x16x32_bf16 v[112:115], v[88:91], v[36:39], v[112:115]
    v_mfma_f32_16x16x32_bf16 v[120:123], v[88:91], v[140:143], v[120:123]
    ds_read_b64_tr_b16 v[88:89], v144 offset:25600
    ds_read_b64_tr_b16 v[90:91], v144 offset:26880
    s_waitcnt lgkmcnt(14)
    v_mfma_f32_16x16x32_bf16 v[116:119], v[92:95], v[140:143], v[116:119]
    ds_read_b64_tr_b16 v[92:93], v144 offset:25632
    ds_read_b64_tr_b16 v[94:95], v144 offset:26912
    s_waitcnt lgkmcnt(14)
    v_mfma_f32_16x16x32_bf16 v[96:99], v[64:67], v[40:43], v[96:99]
    v_mfma_f32_16x16x32_bf16 v[176:179], v[140:143], v[40:43], v[176:179]
    ds_read_b64_tr_b16 v[64:65], v144 offset:25664
    ds_read_b64_tr_b16 v[66:67], v144 offset:26944
    s_waitcnt lgkmcnt(14)
    v_mfma_f32_16x16x32_bf16 v[100:103], v[68:71], v[40:43], v[100:103]
    ds_read_b64_tr_b16 v[68:69], v144 offset:25696
    ds_read_b64_tr_b16 v[70:71], v144 offset:26976
    s_waitcnt lgkmcnt(14)
    v_mfma_f32_16x16x32_bf16 v[104:107], v[72:75], v[40:43], v[104:107]
    v_mfma_f32_16x16x32_bf16 v[180:183], v[40:43], v[40:43], v[180:183]
    ds_read_b64_tr_b16 v[72:73], v144 offset:25728
    ds_read_b64_tr_b16 v[74:75], v144 offset:27008
    s_waitcnt lgkmcnt(14)
    v_mfma_f32_16x16x32_bf16 v[108:111], v[76:79], v[40:43], v[108:111]
    ds_read_b64_tr_b16 v[76:77], v145 offset:25600
    ds_read_b64_tr_b16 v[78:79], v145 offset:26880
    s_waitcnt lgkmcnt(14)
    v_mfma_f32_16x16x32_bf16 v[112:115], v[80:83], v[40:43], v[112:115]
    v_mfma_f32_16x16x32_bf16 v[120:123], v[80:83], v[140:143], v[120:123]
    ds_read_b64_tr_b16 v[80:81], v144 offset:30720
    ds_read_b64_tr_b16 v[82:83], v144 offset:32000
    s_waitcnt lgkmcnt(14)
    v_mfma_f32_16x16x32_bf16 v[116:119], v[84:87], v[140:143], v[116:119]
    ds_read_b64_tr_b16 v[84:85], v144 offset:30752
    ds_read_b64_tr_b16 v[86:87], v144 offset:32032
    s_waitcnt lgkmcnt(14)
    v_mfma_f32_16x16x32_bf16 v[96:99], v[88:91], v[44:47], v[96:99]
    v_mfma_f32_16x16x32_bf16 v[176:179], v[140:143], v[44:47], v[176:179]
    ds_read_b64_tr_b16 v[88:89], v144 offset:30784
    ds_read_b64_tr_b16 v[90:91], v144 offset:32064
    s_waitcnt lgkmcnt(14)
    v_mfma_f32_16x16x32_bf16 v[100:103], v[92:95], v[44:47], v[100:103]
    ds_read_b64_tr_b16 v[92:93], v144 offset:30816
    ds_read_b64_tr_b16 v[94:95], v144 offset:32096
    s_waitcnt lgkmcnt(14)
    v_mfma_f32_16x16x32_bf16 v[104:107], v[64:67], v[44:47], v[104:107]
    v_mfma_f32_16x16x32_bf16 v[180:183], v[44:47], v[44:47], v[180:183]
    ds_read_b64_tr_b16 v[64:65], v144 offset:30848
    ds_read_b64_tr_b16 v[66:67], v144 offset:32128
    s_waitcnt lgkmcnt(14)
    v_mfma_f32_16x16x32_bf16 v[108:111], v[68:71], v[44:47], v[108:111]
    ds_read_b64_tr_b16 v[68:69], v145 offset:30720
    ds_read_b64_tr_b16 v[70:71], v145 offset:32000
    s_waitcnt lgkmcnt(14)
    v_mfma_f32_16x16x32_bf16 v[112:115], v[72:75], v[44:47], v[112:115]
    v_mfma_f32_16x16x32_bf16 v[120:123], v[72:75], v[140:143], v[120:123]
    ds_read_b64_tr_b16 v[72:73], v144 offset:35840
    ds_read_b64_tr_b16 v[74:75], v144 offset:37120
    s_waitcnt lgkmcnt(14)
    v_mfma_f32_16x16x32_bf16 v[116:119], v[76:79], v[140:143], v[116:119]
    ds_read_b64_tr_b16 v[76:77], v144 offset:35872
    ds_read_b64_tr_b16 v[78:79], v144 offset:37152
    s_waitcnt lgkmcnt(14)
    v_mfma_f32_16x16x32_bf16 v[96:99], v[80:83], v[48:51], v[96:99]
    v_mfma_f32_16x16x32_bf16 v[176:179], v[140:143], v[48:51], v[176:179]
    ds_read_b64_tr_b16 v[80:81], v144 offset:35904
    ds_read_b64_tr_b16 v[82:83], v144 offset:37184
    s_waitcnt lgkmcnt(14)
    v_mfma_f32_16x16x32_bf16 v[100:103], v[84:87], v[48:51], v[100:103]
    ds_read_b64_tr_b16 v[84:85], v144 offset:35936
    ds_read_b64_tr_b16 v[86:87], v144 offset:37216
    s_waitcnt lgkmcnt(14)
    v_mfma_f32_16x16x32_bf16 v[104:107], v[88:91], v[48:51], v[104:107]
    v_mfma_f32_16x16x32_bf16 v[180:183], v[48:51], v[48:51], v[180:183]
    ds_read_b64_tr_b16 v[88:89], v144 offset:35968
    ds_read_b64_tr_b16 v[90:91], v144 offset:37248
    s_waitcnt lgkmcnt(14)
    v_mfma_f32_16x16x32_bf16 v[108:111], v[92:95], v[48:51], v[108:111]
    ds_read_b64_tr_b16 v[92:93], v145 offset:35840
    ds_read_b64_tr_b16 v[94:95], v145 offset:37120
    s_waitcnt lgkmcnt(14)
    v_mfma_f32_16x16x32_bf16 v[112:115], v[64:67], v[48:51], v[112:115]
    v_mfma_f32_16x16x32_bf16 v[120:123], v[64:67], v[140:143], v[120:123]
    ds_read_b64_tr_b16 v[64:65], v144 offset:40960
    ds_read_b64_tr_b16 v[66:67], v144 offset:42240
    s_waitcnt lgkmcnt(14)
    v_mfma_f32_16x16x32_bf16 v[116:119], v[68:71], v[140:143], v[116:119]
    ds_read_b64_tr_b16 v[68:69], v144 offset:40992
    ds_read_b64_tr_b16 v[70:71], v144 offset:42272
    s_waitcnt lgkmcnt(14)
    v_mfma_f32_16x16x32_bf16 v[96:99], v[72:75], v[52:55], v[96:99]
    v_mfma_f32_16x16x32_bf16 v[176:179], v[140:143], v[52:55], v[176:179]
    ds_read_b64_tr_b16 v[72:73], v144 offset:41024
    ds_read_b64_tr_b16 v[74:75], v144 offset:42304
    s_waitcnt lgkmcnt(14)
    v_mfma_f32_16x16x32_bf16 v[100:103], v[76:79], v[52:55], v[100:103]
    ds_read_b64_tr_b16 v[76:77], v144 offset:41056
    ds_read_b64_tr_b16 v[78:79], v144 offset:42336
    s_waitcnt lgkmcnt(14)
    v_mfma_f32_16x16x32_bf16 v[104:107], v[80:83], v[52:55], v[104:107]
    v_mfma_f32_16x16x32_bf16 v[180:183], v[52:55], v[52:55], v[180:183]
    ds_read_b64_tr_b16 v[80:81], v144 offset:41088
    ds_read_b64_tr_b16 v[82:83], v144 offset:42368
    s_waitcnt lgkmcnt(14)
    v_mfma_f32_16x16x32_bf16 v[108:111], v[84:87], v[52:55], v[108:111]
    ds_read_b64_tr_b16 v[84:85], v145 offset:40960
    ds_read_b64_tr_b16 v[86:87], v145 offset:42240
    s_waitcnt lgkmcnt(14)
    v_mfma_f32_16x16x32_bf16 v[112:115], v[88:91], v[52:55], v[112:115]
    v_mfma_f32_16x16x32_bf16 v[120:123], v[88:91], v[140:143], v[120:123]
    ds_read_b64_tr_b16 v[88:89], v144 offset:46080
    ds_read_b64_tr_b16 v[90:91], v144 offset:47360
    s_waitcnt lgkmcnt(14)
    v_mfma_f32_16x16x32_bf16 v[116:119], v[92:95], v[140:143], v[116:119]
    ds_read_b64_tr_b16 v[92:93], v144 offset:46112
    ds_read_b64_tr_b16 v[94:95], v144 offset:47392
    s_waitcnt lgkmcnt(14)
    v_mfma_f32_16x16x32_bf16 v[96:99], v[64:67], v[56:59], v[96:99]
    v_mfma_f32_16x16x32_bf16 v[176:179], v[140:143], v[56:59], v[176:179]
    ds_read_b64_tr_b16 v[64:65], v144 offset:46144
    ds_read_b64_tr_b16 v[66:67], v144 offset:47424
    s_waitcnt lgkmcnt(14)
    v_mfma_f32_16x16x32_bf16 v[100:103], v[68:71], v[56:59], v[100:103]
    ds_read_b64_tr_b16 v[68:69], v144 offset:46176
    ds_read_b64_tr_b16 v[70:71], v144 offset:47456
    s_waitcnt lgkmcnt(14)
    v_mfma_f32_16x16x32_bf16 v[104:107], v[72:75], v[56:59], v[104:107]
    v_mfma_f32_16x16x32_bf16 v[180:183], v[56:59], v[56:59], v[180:183]
    ds_read_b64_tr_b16 v[72:73], v144 offset:46208
    ds_read_b64_tr_b16 v[74:75], v144 offset:47488
    s_waitcnt lgkmcnt(14)
    v_mfma_f32_16x16x32_bf16 v[108:111], v[76:79], v[56:59], v[108:111]
    ds_read_b64_tr_b16 v[76:77], v145 offset:46080
    ds_read_b64_tr_b16 v[78:79], v145 offset:47360
    s_waitcnt lgkmcnt(14)
    v_mfma_f32_16x16x32_bf16 v[112:115], v[80:83], v[56:59], v[112:115]
    v_mfma_f32_16x16x32_bf16 v[120:123], v[80:83], v[140:143], v[120:123]
    s_waitcnt lgkmcnt(12)
    v_mfma_f32_16x16x32_bf16 v[116:119], v[84:87], v[140:143], v[116:119]
    s_waitcnt lgkmcnt(10)
    v_mfma_f32_16x16x32_bf16 v[96:99], v[88:91], v[60:63], v[96:99]
    v_mfma_f32_16x16x32_bf16 v[176:179], v[140:143], v[60:63], v[176:179]
    s_waitcnt lgkmcnt(8)
    v_mfma_f32_16x16x32_bf16 v[100:103], v[92:95], v[60:63], v[100:103]
    s_waitcnt lgkmcnt(6)
    v_mfma_f32_16x16x32_bf16 v[104:107], v[64:67], v[60:63], v[104:107]
    v_mfma_f32_16x16x32_bf16 v[180:183], v[60:63], v[60:63], v[180:183]
    s_waitcnt lgkmcnt(4)
    v_mfma_f32_16x16x32_bf16 v[108:111], v[68:71], v[60:63], v[108:111]
    s_waitcnt lgkmcnt(2)
    v_mfma_f32_16x16x32_bf16 v[112:115], v[72:75], v[60:63], v[112:115]
    v_mfma_f32_16x16x32_bf16 v[120:123], v[72:75], v[140:143], v[120:123]
    s_waitcnt lgkmcnt(0)
    v_mfma_f32_16x16x32_bf16 v[116:119], v[76:79], v[140:143], v[116:119]
    s_mul_i32 s28, s5, 320
    s_add_u32 s28, s28, 163136
    v_lshl_add_u32 v151, v3, 4, s28
    s_lshl_b32 s29, s4, 6
    v_add_u32 v152, s29, v151
    s_nop 2
    ds_write_b128 v152, v[116:119]
    ds_write_b128 v151, v[120:123] offset:256
    s_branch interleave_layers__grouped_kv_mqa__mixer_channel_mlp__prompt_kernel_m236
interleave_layers__grouped_kv_mqa__mixer_channel_mlp__prompt_kernel_m135:
    s_mul_i32 s28, s5, 10240
    v_add_u32 v144, s28, v4
    v_add_u32 v145, 61440, v144
    ds_read_b128 v[64:67], v144 offset:0
    ds_read_b128 v[68:71], v144 offset:20480
    ds_read_b128 v[72:75], v144 offset:40960
    ds_read_b128 v[76:79], v145 offset:0
    ds_read_b128 v[80:83], v145 offset:20480
    ds_read_b128 v[84:87], v144 offset:1024
    ds_read_b128 v[88:91], v144 offset:21504
    ds_read_b128 v[92:95], v144 offset:41984
    s_waitcnt lgkmcnt(7) vmcnt(9)
    v_mfma_f32_16x16x32_bf16 v[96:99], v[64:67], v[24:27], 0
    v_mfma_f32_16x16x32_bf16 v[176:179], v[140:143], v[24:27], 0
    ds_read_b128 v[64:67], v145 offset:1024
    s_waitcnt lgkmcnt(7)
    v_mfma_f32_16x16x32_bf16 v[100:103], v[68:71], v[24:27], 0
    ds_read_b128 v[68:71], v145 offset:21504
    s_waitcnt lgkmcnt(7)
    v_mfma_f32_16x16x32_bf16 v[104:107], v[72:75], v[24:27], 0
    v_mfma_f32_16x16x32_bf16 v[180:183], v[24:27], v[24:27], 0
    ds_read_b128 v[72:75], v144 offset:2048
    s_waitcnt lgkmcnt(7)
    v_mfma_f32_16x16x32_bf16 v[108:111], v[76:79], v[24:27], 0
    ds_read_b128 v[76:79], v144 offset:22528
    s_waitcnt lgkmcnt(7)
    v_mfma_f32_16x16x32_bf16 v[112:115], v[80:83], v[24:27], 0
    ds_read_b128 v[80:83], v144 offset:43008
    s_waitcnt lgkmcnt(7) vmcnt(8)
    v_mfma_f32_16x16x32_bf16 v[96:99], v[84:87], v[28:31], v[96:99]
    v_mfma_f32_16x16x32_bf16 v[176:179], v[140:143], v[28:31], v[176:179]
    ds_read_b128 v[84:87], v145 offset:2048
    s_waitcnt lgkmcnt(7)
    v_mfma_f32_16x16x32_bf16 v[100:103], v[88:91], v[28:31], v[100:103]
    ds_read_b128 v[88:91], v145 offset:22528
    s_waitcnt lgkmcnt(7)
    v_mfma_f32_16x16x32_bf16 v[104:107], v[92:95], v[28:31], v[104:107]
    v_mfma_f32_16x16x32_bf16 v[180:183], v[28:31], v[28:31], v[180:183]
    ds_read_b128 v[92:95], v144 offset:3072
    s_waitcnt lgkmcnt(7)
    v_mfma_f32_16x16x32_bf16 v[108:111], v[64:67], v[28:31], v[108:111]
    ds_read_b128 v[64:67], v144 offset:23552
    s_waitcnt lgkmcnt(7)
    v_mfma_f32_16x16x32_bf16 v[112:115], v[68:71], v[28:31], v[112:115]
    ds_read_b128 v[68:71], v144 offset:44032
    s_waitcnt lgkmcnt(7) vmcnt(7)
    v_mfma_f32_16x16x32_bf16 v[96:99], v[72:75], v[32:35], v[96:99]
    v_mfma_f32_16x16x32_bf16 v[176:179], v[140:143], v[32:35], v[176:179]
    ds_read_b128 v[72:75], v145 offset:3072
    s_waitcnt lgkmcnt(7)
    v_mfma_f32_16x16x32_bf16 v[100:103], v[76:79], v[32:35], v[100:103]
    ds_read_b128 v[76:79], v145 offset:23552
    s_waitcnt lgkmcnt(7)
    v_mfma_f32_16x16x32_bf16 v[104:107], v[80:83], v[32:35], v[104:107]
    v_mfma_f32_16x16x32_bf16 v[180:183], v[32:35], v[32:35], v[180:183]
    ds_read_b128 v[80:83], v144 offset:4096
    s_waitcnt lgkmcnt(7)
    v_mfma_f32_16x16x32_bf16 v[108:111], v[84:87], v[32:35], v[108:111]
    ds_read_b128 v[84:87], v144 offset:24576
    s_waitcnt lgkmcnt(7)
    v_mfma_f32_16x16x32_bf16 v[112:115], v[88:91], v[32:35], v[112:115]
    ds_read_b128 v[88:91], v144 offset:45056
    s_waitcnt lgkmcnt(7) vmcnt(6)
    v_mfma_f32_16x16x32_bf16 v[96:99], v[92:95], v[36:39], v[96:99]
    v_mfma_f32_16x16x32_bf16 v[176:179], v[140:143], v[36:39], v[176:179]
    ds_read_b128 v[92:95], v145 offset:4096
    s_waitcnt lgkmcnt(7)
    v_mfma_f32_16x16x32_bf16 v[100:103], v[64:67], v[36:39], v[100:103]
    ds_read_b128 v[64:67], v145 offset:24576
    s_waitcnt lgkmcnt(7)
    v_mfma_f32_16x16x32_bf16 v[104:107], v[68:71], v[36:39], v[104:107]
    v_mfma_f32_16x16x32_bf16 v[180:183], v[36:39], v[36:39], v[180:183]
    ds_read_b128 v[68:71], v144 offset:5120
    s_waitcnt lgkmcnt(7)
    v_mfma_f32_16x16x32_bf16 v[108:111], v[72:75], v[36:39], v[108:111]
    ds_read_b128 v[72:75], v144 offset:25600
    s_waitcnt lgkmcnt(7)
    v_mfma_f32_16x16x32_bf16 v[112:115], v[76:79], v[36:39], v[112:115]
    ds_read_b128 v[76:79], v144 offset:46080
    s_waitcnt lgkmcnt(7) vmcnt(5)
    v_mfma_f32_16x16x32_bf16 v[96:99], v[80:83], v[40:43], v[96:99]
    v_mfma_f32_16x16x32_bf16 v[176:179], v[140:143], v[40:43], v[176:179]
    ds_read_b128 v[80:83], v145 offset:5120
    s_waitcnt lgkmcnt(7)
    v_mfma_f32_16x16x32_bf16 v[100:103], v[84:87], v[40:43], v[100:103]
    ds_read_b128 v[84:87], v145 offset:25600
    s_waitcnt lgkmcnt(7)
    v_mfma_f32_16x16x32_bf16 v[104:107], v[88:91], v[40:43], v[104:107]
    v_mfma_f32_16x16x32_bf16 v[180:183], v[40:43], v[40:43], v[180:183]
    ds_read_b128 v[88:91], v144 offset:6144
    s_waitcnt lgkmcnt(7)
    v_mfma_f32_16x16x32_bf16 v[108:111], v[92:95], v[40:43], v[108:111]
    ds_read_b128 v[92:95], v144 offset:26624
    s_waitcnt lgkmcnt(7)
    v_mfma_f32_16x16x32_bf16 v[112:115], v[64:67], v[40:43], v[112:115]
    ds_read_b128 v[64:67], v144 offset:47104
    s_waitcnt lgkmcnt(7) vmcnt(4)
    v_mfma_f32_16x16x32_bf16 v[96:99], v[68:71], v[44:47], v[96:99]
    v_mfma_f32_16x16x32_bf16 v[176:179], v[140:143], v[44:47], v[176:179]
    ds_read_b128 v[68:71], v145 offset:6144
    s_waitcnt lgkmcnt(7)
    v_mfma_f32_16x16x32_bf16 v[100:103], v[72:75], v[44:47], v[100:103]
    ds_read_b128 v[72:75], v145 offset:26624
    s_waitcnt lgkmcnt(7)
    v_mfma_f32_16x16x32_bf16 v[104:107], v[76:79], v[44:47], v[104:107]
    v_mfma_f32_16x16x32_bf16 v[180:183], v[44:47], v[44:47], v[180:183]
    ds_read_b128 v[76:79], v144 offset:7168
    s_waitcnt lgkmcnt(7)
    v_mfma_f32_16x16x32_bf16 v[108:111], v[80:83], v[44:47], v[108:111]
    ds_read_b128 v[80:83], v144 offset:27648
    s_waitcnt lgkmcnt(7)
    v_mfma_f32_16x16x32_bf16 v[112:115], v[84:87], v[44:47], v[112:115]
    ds_read_b128 v[84:87], v144 offset:48128
    s_waitcnt lgkmcnt(7) vmcnt(3)
    v_mfma_f32_16x16x32_bf16 v[96:99], v[88:91], v[48:51], v[96:99]
    v_mfma_f32_16x16x32_bf16 v[176:179], v[140:143], v[48:51], v[176:179]
    ds_read_b128 v[88:91], v145 offset:7168
    s_waitcnt lgkmcnt(7)
    v_mfma_f32_16x16x32_bf16 v[100:103], v[92:95], v[48:51], v[100:103]
    ds_read_b128 v[92:95], v145 offset:27648
    s_waitcnt lgkmcnt(7)
    v_mfma_f32_16x16x32_bf16 v[104:107], v[64:67], v[48:51], v[104:107]
    v_mfma_f32_16x16x32_bf16 v[180:183], v[48:51], v[48:51], v[180:183]
    ds_read_b128 v[64:67], v144 offset:8192
    s_waitcnt lgkmcnt(7)
    v_mfma_f32_16x16x32_bf16 v[108:111], v[68:71], v[48:51], v[108:111]
    ds_read_b128 v[68:71], v144 offset:28672
    s_waitcnt lgkmcnt(7)
    v_mfma_f32_16x16x32_bf16 v[112:115], v[72:75], v[48:51], v[112:115]
    ds_read_b128 v[72:75], v144 offset:49152
    s_waitcnt lgkmcnt(7) vmcnt(2)
    v_mfma_f32_16x16x32_bf16 v[96:99], v[76:79], v[52:55], v[96:99]
    v_mfma_f32_16x16x32_bf16 v[176:179], v[140:143], v[52:55], v[176:179]
    ds_read_b128 v[76:79], v145 offset:8192
    s_waitcnt lgkmcnt(7)
    v_mfma_f32_16x16x32_bf16 v[100:103], v[80:83], v[52:55], v[100:103]
    ds_read_b128 v[80:83], v145 offset:28672
    s_waitcnt lgkmcnt(7)
    v_mfma_f32_16x16x32_bf16 v[104:107], v[84:87], v[52:55], v[104:107]
    v_mfma_f32_16x16x32_bf16 v[180:183], v[52:55], v[52:55], v[180:183]
    ds_read_b128 v[84:87], v144 offset:9216
    s_waitcnt lgkmcnt(7)
    v_mfma_f32_16x16x32_bf16 v[108:111], v[88:91], v[52:55], v[108:111]
    ds_read_b128 v[88:91], v144 offset:29696
    s_waitcnt lgkmcnt(7)
    v_mfma_f32_16x16x32_bf16 v[112:115], v[92:95], v[52:55], v[112:115]
    ds_read_b128 v[92:95], v144 offset:50176
    s_waitcnt lgkmcnt(7) vmcnt(1)
    v_mfma_f32_16x16x32_bf16 v[96:99], v[64:67], v[56:59], v[96:99]
    v_mfma_f32_16x16x32_bf16 v[176:179], v[140:143], v[56:59], v[176:179]
    ds_read_b128 v[64:67], v145 offset:9216
    s_waitcnt lgkmcnt(7)
    v_mfma_f32_16x16x32_bf16 v[100:103], v[68:71], v[56:59], v[100:103]
    ds_read_b128 v[68:71], v145 offset:29696
    s_waitcnt lgkmcnt(7)
    v_mfma_f32_16x16x32_bf16 v[104:107], v[72:75], v[56:59], v[104:107]
    v_mfma_f32_16x16x32_bf16 v[180:183], v[56:59], v[56:59], v[180:183]
    s_waitcnt lgkmcnt(6)
    v_mfma_f32_16x16x32_bf16 v[108:111], v[76:79], v[56:59], v[108:111]
    s_waitcnt lgkmcnt(5)
    v_mfma_f32_16x16x32_bf16 v[112:115], v[80:83], v[56:59], v[112:115]
    s_waitcnt lgkmcnt(4) vmcnt(0)
    v_mfma_f32_16x16x32_bf16 v[96:99], v[84:87], v[60:63], v[96:99]
    v_mfma_f32_16x16x32_bf16 v[176:179], v[140:143], v[60:63], v[176:179]
    s_waitcnt lgkmcnt(3)
    v_mfma_f32_16x16x32_bf16 v[100:103], v[88:91], v[60:63], v[100:103]
    s_waitcnt lgkmcnt(2)
    v_mfma_f32_16x16x32_bf16 v[104:107], v[92:95], v[60:63], v[104:107]
    v_mfma_f32_16x16x32_bf16 v[180:183], v[60:63], v[60:63], v[180:183]
    s_waitcnt lgkmcnt(1)
    v_mfma_f32_16x16x32_bf16 v[108:111], v[64:67], v[60:63], v[108:111]
    s_waitcnt lgkmcnt(0)
    v_mfma_f32_16x16x32_bf16 v[112:115], v[68:71], v[60:63], v[112:115]
interleave_layers__grouped_kv_mqa__mixer_channel_mlp__prompt_kernel_m236:
    s_cmp_eq_u32 s12, 0
    s_cbranch_scc1 interleave_layers__grouped_kv_mqa__mixer_channel_mlp__prompt_kernel_l337
    s_lshr_b32 s28, s7, 1
    s_cmp_lg_u32 s28, s4
    s_cbranch_scc1 interleave_layers__grouped_kv_mqa__mixer_channel_mlp__prompt_kernel_nkf39
    s_waitcnt vmcnt(0)
    s_add_u32 s28, s13, 1
    v_mov_b32 v149, s28
    s_lshl_b32 s29, s6, 6
    s_lshl_b32 s30, s7, 3
    s_add_u32 s29, s29, s30
    s_lshl_b32 s30, s5, 2
    s_add_u32 s29, s29, s30
    s_add_u32 s29, s29, 16384
    v_mov_b32 v150, s29
    s_mov_b64 exec, 1
    buffer_store_dword v149, v150, s[8:11], 0 offen sc1
    s_mov_b64 exec, -1
interleave_layers__grouped_kv_mqa__mixer_channel_mlp__prompt_kernel_nkf39:
    s_mov_b32 s43, 128000
    s_branch interleave_layers__grouped_kv_mqa__mixer_channel_mlp__prompt_kernel_l438
interleave_layers__grouped_kv_mqa__mixer_channel_mlp__prompt_kernel_l337:
    s_waitcnt vmcnt(0)
    s_cmp_eq_u32 s50, 0
    s_cbranch_scc1 interleave_layers__grouped_kv_mqa__mixer_channel_mlp__prompt_kernel_cfd40
    s_lshl_b32 s34, s43, 12
    s_add_u32 s34, s34, 128000
    v_lshrrev_b32 v200, 2, v2
    v_and_b32 v201, 3, v1
    s_cmp_eq_u32 s50, 2
    s_cbranch_scc1 interleave_layers__grouped_kv_mqa__mixer_channel_mlp__prompt_kernel_cf241
    v_lshl_add_u32 v200, v6, 3, v200
    v_lshlrev_b32 v200, 7, v200
    v_and_b32 v202, 1, v3
    v_lshl_add_u32 v200, v202, 5, v200
    v_lshl_add_u32 v200, v201, 3, v200
    v_add_u32 v200, s34, v200
    ds_read_b64_tr_b16 v[204:205], v200 offset:0
    ds_read_b64_tr_b16 v[206:207], v200 offset:512
    ds_read_b64_tr_b16 v[208:209], v200 offset:2048
    ds_read_b64_tr_b16 v[210:211], v200 offset:2560
    ds_read_b64_tr_b16 v[212:213], v200 offset:64
    ds_read_b64_tr_b16 v[214:215], v200 offset:576
    ds_read_b64_tr_b16 v[216:217], v200 offset:2112
    ds_read_b64_tr_b16 v[218:219], v200 offset:2624
    s_waitcnt lgkmcnt(0)
    s_add_u32 s32, s51, 0
    buffer_store_dwordx4 v[204:207], v4, s[8:11], s32 offen sc1
    s_add_u32 s32, s51, 1024
    buffer_store_dwordx4 v[208:211], v4, s[8:11], s32 offen sc1
    s_add_u32 s32, s51, 40960
    buffer_store_dwordx4 v[212:215], v4, s[8:11], s32 offen sc1
    s_add_u32 s32, s51, 41984
    buffer_store_dwordx4 v[216:219], v4, s[8:11], s32 offen sc1
    s_branch interleave_layers__grouped_kv_mqa__mixer_channel_mlp__prompt_kernel_cfd40
interleave_layers__grouped_kv_mqa__mixer_channel_mlp__prompt_kernel_cf241:
    v_lshl_add_u32 v200, v3, 3, v200
    v_lshlrev_b32 v200, 7, v200
    v_lshl_add_u32 v200, v201, 3, v200
    v_add_u32 v200, s34, v200
    ds_read_b64_tr_b16 v[204:205], v200 offset:0
    ds_read_b64_tr_b16 v[206:207], v200 offset:512
    ds_read_b64_tr_b16 v[208:209], v200 offset:32
    ds_read_b64_tr_b16 v[210:211], v200 offset:544
    ds_read_b64_tr_b16 v[212:213], v200 offset:64
    ds_read_b64_tr_b16 v[214:215], v200 offset:576
    ds_read_b64_tr_b16 v[216:217], v200 offset:96
    ds_read_b64_tr_b16 v[218:219], v200 offset:608
    s_waitcnt lgkmcnt(0)
    s_mov_b32 s32, s51
    buffer_store_dwordx4 v[204:207], v4, s[8:11], s32 offen sc1
    s_add_u32 s32, s32, s57
    buffer_store_dwordx4 v[208:211], v4, s[8:11], s32 offen sc1
    s_add_u32 s32, s32, s57
    buffer_store_dwordx4 v[212:215], v4, s[8:11], s32 offen sc1
    s_add_u32 s32, s32, s57
    buffer_store_dwordx4 v[216:219], v4, s[8:11], s32 offen sc1
interleave_layers__grouped_kv_mqa__mixer_channel_mlp__prompt_kernel_cfd40:
    s_mov_b32 s43, 102400
interleave_layers__grouped_kv_mqa__mixer_channel_mlp__prompt_kernel_l438:
    v_and_b32 v150, 3, v1
    v_mov_b32 v147, v180
    v_cmp_eq_u32 vcc, 1, v150
    s_nop 1
    v_cndmask_b32 v147, v147, v181, vcc
    v_cmp_eq_u32 vcc, 2, v150
    s_nop 1
    v_cndmask_b32 v147, v147, v182, vcc
    v_cmp_eq_u32 vcc, 3, v150
    s_nop 1
    v_cndmask_b32 v147, v147, v183, vcc
    v_mov_b32 v146, v176
    s_lshl_b32 s28, s4, 8
    s_lshl_b32 s29, s5, 7
    s_add_u32 s28, s28, s29
    s_add_u32 s28, s28, 152576
    v_lshl_add_u32 v150, v2, 3, s28
    s_mov_b32 exec_lo, 0x00f0000f
    s_mov_b32 exec_hi, 0xf0000f00
    ds_write_b64 v150, v[146:147]
    s_mov_b64 exec, -1
    s_mul_i32 s28, s4, 5120
    s_add_u32 s28, s28, s43
    v_add_u32 v153, s28, v4
    s_cmp_eq_u32 s5, 1
    s_cbranch_scc1 interleave_layers__grouped_kv_mqa__mixer_channel_mlp__prompt_kernel_r142
    ds_write_b128 v153, v[108:111] offset:3072
    ds_write_b128 v153, v[112:115] offset:4096
    s_branch interleave_layers__grouped_kv_mqa__mixer_channel_mlp__prompt_kernel_r243
interleave_layers__grouped_kv_mqa__mixer_channel_mlp__prompt_kernel_r142:
    ds_write_b128 v153, v[96:99] offset:0
    ds_write_b128 v153, v[100:103] offset:1024
    ds_write_b128 v153, v[104:107] offset:2048
    v_mov_b32 v96, v108
    v_mov_b32 v97, v109
    v_mov_b32 v98, v110
    v_mov_b32 v99, v111
    v_mov_b32 v100, v112
    v_mov_b32 v101, v113
    v_mov_b32 v102, v114
    v_mov_b32 v103, v115
interleave_layers__grouped_kv_mqa__mixer_channel_mlp__prompt_kernel_r243:
    s_waitcnt lgkmcnt(0)
    s_barrier
    s_lshl_b32 s28, s4, 8
    s_add_u32 s28, s28, 152576
    v_lshl_add_u32 v150, v2, 3, s28
    ds_read_b64 v[154:155], v150
    ds_read_b64 v[156:157], v150 offset:128
    s_mul_i32 s28, s5, 192
    s_add_u32 s28, s28, 163136
    v_lshl_add_u32 v151, v3, 4, s28
    ds_read_b128 v[36:39], v151 offset:0
    ds_read_b128 v[40:43], v151 offset:320
    ds_read_b128 v[44:47], v151 offset:64
    ds_read_b128 v[48:51], v151 offset:384
    ds_read_b128 v[52:55], v151 offset:128
    ds_read_b128 v[56:59], v151 offset:448
    s_mul_i32 s29, s5, 3072
    v_add_u32 v153, s29, v153
    ds_read_b128 v[24:27], v153 offset:0
    ds_read_b128 v[28:31], v153 offset:1024
    ds_read_b128 v[32:35], v153 offset:2048
    s_waitcnt lgkmcnt(0)
    v_add_f32 v96, v96, v24
    v_add_f32 v97, v97, v25
    v_add_f32 v98, v98, v26
    v_add_f32 v99, v99, v27
    v_add_f32 v100, v100, v28
    v_add_f32 v101, v101, v29
    v_add_f32 v102, v102, v30
    v_add_f32 v103, v103, v31
    v_add_f32 v104, v104, v32
    v_add_f32 v105, v105, v33
    v_add_f32 v106, v106, v34
    v_add_f32 v107, v107, v35
    v_add_f32 v154, v154, v156
    v_add_f32 v155, v155, v157
    v_mul_f32 v158, 0x3acccccd, v154
    v_mul_f32 v155, 0x3acccccd, v155
    v_fma_f32 v155, -v158, v158, v155
    v_max_f32 v155, 0, v155
    v_add_f32 v155, 0x3727c5ac, v155
    v_rsq_f32 v159, v155
    s_nop 0
    v_mul_f32 v158, v158, v159
    v_mul_f32 v160, 0x3ea52b5c, v159
    v_mul_f32 v161, 0x3ea52b5c, v158
    s_lshl_b32 s28, s4, 4
    v_add_u32 v162, s28, v2
    v_mul_u32_u24 v162, 160, v162
    v_lshl_add_u32 v162, v3, 3, v162
    s_mul_i32 s28, s5, 96
    s_add_u32 s28, s28, 0
    v_add_u32 v162, s28, v162
    v_add_f32 v36, v36, v40
    v_mul_f32 v96, v96, v160
    v_fma_f32 v96, -v161, v36, v96
    v_add_f32 v37, v37, v41
    v_mul_f32 v97, v97, v160
    v_fma_f32 v97, -v161, v37, v97
    v_add_f32 v38, v38, v42
    v_mul_f32 v98, v98, v160
    v_fma_f32 v98, -v161, v38, v98
    v_add_f32 v39, v39, v43
    v_mul_f32 v99, v99, v160
    v_fma_f32 v99, -v161, v39, v99
    v_cvt_pk_bf16_f32 v96, v96, v97
    v_cvt_pk_bf16_f32 v97, v98, v99
    ds_write_b64 v162, v[96:97] offset:0
    v_add_f32 v44, v44, v48
    v_mul_f32 v100, v100, v160
    v_fma_f32 v100, -v161, v44, v100
    v_add_f32 v45, v45, v49
    v_mul_f32 v101, v101, v160
    v_fma_f32 v101, -v161, v45, v101
    v_add_f32 v46, v46, v50
    v_mul_f32 v102, v102, v160
    v_fma_f32 v102, -v161, v46, v102
    v_add_f32 v47, v47, v51
    v_mul_f32 v103, v103, v160
    v_fma_f32 v103, -v161, v47, v103
    v_cvt_pk_bf16_f32 v100, v100, v101
    v_cvt_pk_bf16_f32 v101, v102, v103
    ds_write_b64 v162, v[100:101] offset:32
    s_cmp_eq_u32 s5, 1
    s_cbranch_scc1 interleave_layers__grouped_kv_mqa__mixer_channel_mlp__prompt_kernel_q344
    v_add_f32 v52, v52, v56
    v_mul_f32 v104, v104, v160
    v_fma_f32 v104, -v161, v52, v104
    v_add_f32 v53, v53, v57
    v_mul_f32 v105, v105, v160
    v_fma_f32 v105, -v161, v53, v105
    v_add_f32 v54, v54, v58
    v_mul_f32 v106, v106, v160
    v_fma_f32 v106, -v161, v54, v106
    v_add_f32 v55, v55, v59
    v_mul_f32 v107, v107, v160
    v_fma_f32 v107, -v161, v55, v107
    v_cvt_pk_bf16_f32 v104, v104, v105
    v_cvt_pk_bf16_f32 v105, v106, v107
    ds_write_b64 v162, v[104:105] offset:64
interleave_layers__grouped_kv_mqa__mixer_channel_mlp__prompt_kernel_q344:
    s_waitcnt lgkmcnt(0)
    s_waitcnt vmcnt(0)
    s_barrier
    s_cmp_lg_u32 s3, 0
    s_cbranch_scc1 interleave_layers__grouped_kv_mqa__mixer_channel_mlp__prompt_kernel_pub45
    s_add_u32 s28, s13, 1
    v_mov_b32 v22, s28
    s_lshl_b32 s29, s6, 8
    s_lshl_b32 s30, s7, 2
    s_add_u32 s29, s29, s30
    v_mov_b32 v21, s29
    s_mov_b64 exec, 1
    buffer_store_dword v22, v21, s[8:11], 0 offen offset:0 sc1
    s_mov_b64 exec, -1
interleave_layers__grouped_kv_mqa__mixer_channel_mlp__prompt_kernel_pub45:
    v_mul_u32_u24 v165, 160, v5
    s_mul_i32 s28, s4, 40
    s_add_u32 s28, s28, 0
    v_add_u32 v165, s28, v165
    v_lshl_add_u32 v166, v6, 4, v165
    ds_read_b64 v[24:25], v166 offset:0
    ds_read_b64 v[26:27], v166 offset:8
    ds_read_b64 v[28:29], v165 offset:32
    ds_read_b64 v[30:31], v166 offset:5120
    ds_read_b64 v[32:33], v166 offset:5128
    ds_read_b64 v[34:35], v165 offset:5152
    v_lshlrev_b32 v164, 3, v1
    v_mov_b32 v217, 0x40000000
    v_cmp_eq_u32 vcc, 0, v6
    s_nop 1
    v_cndmask_b32 v164, v217, v164, vcc
    v_cmp_ge_u32 vcc, 20, v5
    s_nop 1
    v_cndmask_b32 v216, v217, v4, vcc
    s_waitcnt lgkmcnt(0)
    v_cmp_eq_u32 vcc, 0, v6
    s_nop 1
    v_cndmask_b32 v28, 0, v28, vcc
    v_cndmask_b32 v29, 0, v29, vcc
    v_cndmask_b32 v34, 0, v34, vcc
    v_cndmask_b32 v35, 0, v35, vcc
    v_lshlrev_b32 v170, 6, v3
    v_lshl_add_u32 v170, v2, 2, v170
    v_add_u32 v170, 16384, v170
    s_add_u32 s38, s13, 1
    s_lshr_b32 s39, s6, 2
    v_mov_b32 v172, 163780
    v_mov_b32 v173, 0
    ds_write_b32 v172, v173
    s_mov_b32 s49, 0
    s_waitcnt lgkmcnt(0)
    s_cmp_lg_u32 s3, 7
    s_cbranch_scc1 interleave_layers__grouped_kv_mqa__mixer_channel_mlp__prompt_kernel_pw46
    s_lshl_b32 s28, s39, 8
    s_mov_b32 s30, 0
interleave_layers__grouped_kv_mqa__mixer_channel_mlp__prompt_kernel_sg47:
    buffer_load_dword v171, v170, s[8:11], s28 offen sc1
    s_waitcnt vmcnt(0)
    v_subrev_u32 v171, s38, v171
    v_cmp_le_u32 vcc, 32, v171
    s_cbranch_vccz interleave_layers__grouped_kv_mqa__mixer_channel_mlp__prompt_kernel_sgd48
    s_sleep 2
    s_add_u32 s30, s30, 1
    s_cmp_lt_u32 s30, 0x40000
    s_cbranch_scc1 interleave_layers__grouped_kv_mqa__mixer_channel_mlp__prompt_kernel_sg47
interleave_layers__grouped_kv_mqa__mixer_channel_mlp__prompt_kernel_sgd48:
interleave_layers__grouped_kv_mqa__mixer_channel_mlp__prompt_kernel_pw46:
    s_barrier
    s_mul_i32 s33, s12, 229376
    s_add_u32 s33, s33, 32768
    s_mul_i32 s28, s5, 3584
    s_add_u32 s33, s33, s28
    s_mul_i32 s28, s39, 28672
    s_add_u32 s32, s33, s28
    s_add_u32 s33, s33, 229376
    s_mov_b32 s45, s39
    s_add_u32 s45, s45, 1
    s_and_b32 s45, s45, 7
    s_lshl_b32 s46, s45, 8
    buffer_load_dword v171, v170, s[8:11], s46 offen sc1
    s_mov_b32 s44, s45
    buffer_load_dwordx4 v[108:111], v4, s[8:11], s32 offen
    buffer_load_dwordx2 v[120:121], v164, s[8:11], s32 offen offset:3072
    buffer_load_dwordx4 v[112:115], v216, s[8:11], s32 offen offset:1024
    buffer_load_dwordx4 v[116:119], v216, s[8:11], s32 offen offset:2048
    s_add_u32 s32, s32, 7168
    buffer_load_dwordx4 v[122:125], v4, s[8:11], s32 offen
    buffer_load_dwordx2 v[134:135], v164, s[8:11], s32 offen offset:3072
    buffer_load_dwordx4 v[126:129], v216, s[8:11], s32 offen offset:1024
    buffer_load_dwordx4 v[130:133], v216, s[8:11], s32 offen offset:2048
    s_add_u32 s32, s32, 7168
    buffer_load_dwordx4 v[136:139], v4, s[8:11], s32 offen
    buffer_load_dwordx2 v[148:149], v164, s[8:11], s32 offen offset:3072
    buffer_load_dwordx4 v[140:143], v216, s[8:11], s32 offen offset:1024
    buffer_load_dwordx4 v[144:147], v216, s[8:11], s32 offen offset:2048
    s_add_u32 s32, s32, 7168
    v_mov_b32 v68, 0
    v_mov_b32 v69, 0
    v_mov_b32 v70, 0
    v_mov_b32 v71, 0
    v_mov_b32 v72, 0
    v_mov_b32 v73, 0
    v_mov_b32 v74, 0
    v_mov_b32 v75, 0
    v_mov_b32 v76, 0
    v_mov_b32 v77, 0
    v_mov_b32 v78, 0
    v_mov_b32 v79, 0
    v_mov_b32 v80, 0
    v_mov_b32 v81, 0
    v_mov_b32 v82, 0
    v_mov_b32 v83, 0
    v_mov_b32 v84, 0
    v_mov_b32 v85, 0
    v_mov_b32 v86, 0
    v_mov_b32 v87, 0
    v_mov_b32 v88, 0
    v_mov_b32 v89, 0
    v_mov_b32 v90, 0
    v_mov_b32 v91, 0
    v_mov_b32 v92, 0
    v_mov_b32 v93, 0
    v_mov_b32 v94, 0
    v_mov_b32 v95, 0
    v_mov_b32 v96, 0
    v_mov_b32 v97, 0
    v_mov_b32 v98, 0
    v_mov_b32 v99, 0
    v_mov_b32 v104, 0
    v_mov_b32 v105, 0
    v_mov_b32 v106, 0
    v_mov_b32 v107, 0
    v_mov_b32 v158, 0
    v_mov_b32 v159, 0
    v_mov_b32 v160, 0
    v_mov_b32 v161, 0
    s_waitcnt vmcnt(8)
    v_mfma_f32_32x32x16_bf16 v[36:51], v[108:111], v[24:27], 0
    v_mfma_f32_32x32x8_bf16 v[36:51], v[120:121], v[28:29], v[36:51]
    s_nop 7
    s_mov_b32 s34, 0
interleave_layers__grouped_kv_mqa__mixer_channel_mlp__prompt_kernel_al49:
    v_mfma_f32_32x32x16_bf16 v[52:67], v[108:111], v[30:33], 0
    s_nop 1
    v_exp_f32 v36, v36
    v_exp_f32 v37, v37
    v_exp_f32 v38, v38
    v_exp_f32 v39, v39
    v_mfma_f32_32x32x16_bf16 v[84:99], v[158:161], v[104:107], v[84:99]
    buffer_load_dwordx4 v[150:153], v4, s[8:11], s32 offen
    buffer_load_dwordx2 v[162:163], v164, s[8:11], s32 offen offset:3072
    buffer_load_dwordx4 v[154:157], v216, s[8:11], s32 offen offset:1024
    buffer_load_dwordx4 v[158:161], v216, s[8:11], s32 offen offset:2048
    s_add_u32 s32, s32, 7168
    v_exp_f32 v40, v40
    v_exp_f32 v41, v41
    v_exp_f32 v42, v42
    v_exp_f32 v43, v43
    v_cvt_pk_bf16_f32 v100, v36, v37
    v_cvt_pk_bf16_f32 v101, v38, v39
    v_mfma_f32_32x32x8_bf16 v[52:67], v[120:121], v[34:35], v[52:67]
    v_cvt_pk_bf16_f32 v102, v40, v41
    v_cvt_pk_bf16_f32 v103, v42, v43
    v_exp_f32 v44, v44
    v_exp_f32 v45, v45
    v_exp_f32 v46, v46
    v_exp_f32 v47, v47
    v_mfma_f32_32x32x16_bf16 v[68:83], v[112:115], v[100:103], v[68:83]
    v_exp_f32 v48, v48
    v_exp_f32 v49, v49
    v_exp_f32 v50, v50
    v_exp_f32 v51, v51
    v_cvt_pk_bf16_f32 v104, v44, v45
    v_cvt_pk_bf16_f32 v105, v46, v47
    v_cvt_pk_bf16_f32 v106, v48, v49
    v_cvt_pk_bf16_f32 v107, v50, v51
    s_waitcnt vmcnt(8)
    v_mfma_f32_32x32x16_bf16 v[36:51], v[122:125], v[24:27], 0
    v_exp_f32 v52, v52
    v_exp_f32 v53, v53
    v_exp_f32 v54, v54
    v_exp_f32 v55, v55
    v_mfma_f32_32x32x16_bf16 v[68:83], v[116:119], v[104:107], v[68:83]
    v_exp_f32 v56, v56
    v_exp_f32 v57, v57
    v_exp_f32 v58, v58
    v_exp_f32 v59, v59
    v_cvt_pk_bf16_f32 v100, v52, v53
    v_cvt_pk_bf16_f32 v101, v54, v55
    v_mfma_f32_32x32x8_bf16 v[36:51], v[134:135], v[28:29], v[36:51]
    v_cvt_pk_bf16_f32 v102, v56, v57
    v_cvt_pk_bf16_f32 v103, v58, v59
    v_exp_f32 v60, v60
    v_exp_f32 v61, v61
    v_exp_f32 v62, v62
    v_exp_f32 v63, v63
    v_mfma_f32_32x32x16_bf16 v[84:99], v[112:115], v[100:103], v[84:99]
    v_exp_f32 v64, v64
    v_exp_f32 v65, v65
    v_exp_f32 v66, v66
    v_exp_f32 v67, v67
    v_cvt_pk_bf16_f32 v104, v60, v61
    v_cvt_pk_bf16_f32 v105, v62, v63
    v_cvt_pk_bf16_f32 v106, v64, v65
    v_cvt_pk_bf16_f32 v107, v66, v67
    v_mfma_f32_32x32x16_bf16 v[52:67], v[122:125], v[30:33], 0
    v_exp_f32 v36, v36
    v_exp_f32 v37, v37
    v_exp_f32 v38, v38
    v_exp_f32 v39, v39
    v_mfma_f32_32x32x16_bf16 v[84:99], v[116:119], v[104:107], v[84:99]
    v_subrev_u32 v171, s38, v171
    v_cmp_le_u32 vcc, 32, v171
    s_cbranch_vccz interleave_layers__grouped_kv_mqa__mixer_channel_mlp__prompt_kernel_fok50
    s_lshl_b32 s28, s44, 8
    s_mov_b32 s30, 0
interleave_layers__grouped_kv_mqa__mixer_channel_mlp__prompt_kernel_sg51:
    buffer_load_dword v171, v170, s[8:11], s28 offen sc1
    s_waitcnt vmcnt(0)
    v_subrev_u32 v171, s38, v171
    v_cmp_le_u32 vcc, 32, v171
    s_cbranch_vccz interleave_layers__grouped_kv_mqa__mixer_channel_mlp__prompt_kernel_sgd52
    s_sleep 2
    s_add_u32 s30, s30, 1
    s_cmp_lt_u32 s30, 0x40000
    s_cbranch_scc1 interleave_layers__grouped_kv_mqa__mixer_channel_mlp__prompt_kernel_sg51
interleave_layers__grouped_kv_mqa__mixer_channel_mlp__prompt_kernel_sgd52:
interleave_layers__grouped_kv_mqa__mixer_channel_mlp__prompt_kernel_fok50:
    s_cmp_ge_u32 s32, s33
    s_cselect_b32 s28, 229376, 0
    s_sub_u32 s32, s32, s28
    buffer_load_dwordx4 v[108:111], v4, s[8:11], s32 offen
    buffer_load_dwordx2 v[120:121], v164, s[8:11], s32 offen offset:3072
    buffer_load_dwordx4 v[112:115], v216, s[8:11], s32 offen offset:1024
    buffer_load_dwordx4 v[116:119], v216, s[8:11], s32 offen offset:2048
    s_add_u32 s32, s32, 7168
    v_exp_f32 v40, v40
    v_exp_f32 v41, v41
    v_exp_f32 v42, v42
    v_exp_f32 v43, v43
    v_cvt_pk_bf16_f32 v100, v36, v37
    v_cvt_pk_bf16_f32 v101, v38, v39
    v_mfma_f32_32x32x8_bf16 v[52:67], v[134:135], v[34:35], v[52:67]
    v_cvt_pk_bf16_f32 v102, v40, v41
    v_cvt_pk_bf16_f32 v103, v42, v43
    v_exp_f32 v44, v44
    v_exp_f32 v45, v45
    v_exp_f32 v46, v46
    v_exp_f32 v47, v47
    v_mfma_f32_32x32x16_bf16 v[68:83], v[126:129], v[100:103], v[68:83]
    v_exp_f32 v48, v48
    v_exp_f32 v49, v49
    v_exp_f32 v50, v50
    v_exp_f32 v51, v51
    v_cvt_pk_bf16_f32 v104, v44, v45
    v_cvt_pk_bf16_f32 v105, v46, v47
    v_cvt_pk_bf16_f32 v106, v48, v49
    v_cvt_pk_bf16_f32 v107, v50, v51
    s_waitcnt vmcnt(8)
    v_mfma_f32_32x32x16_bf16 v[36:51], v[136:139], v[24:27], 0
    v_exp_f32 v52, v52
    v_exp_f32 v53, v53
    v_exp_f32 v54, v54
    v_exp_f32 v55, v55
    v_mfma_f32_32x32x16_bf16 v[68:83], v[130:133], v[104:107], v[68:83]
    v_exp_f32 v56, v56
    v_exp_f32 v57, v57
    v_exp_f32 v58, v58
    v_exp_f32 v59, v59
    v_cvt_pk_bf16_f32 v100, v52, v53
    v_cvt_pk_bf16_f32 v101, v54, v55
    v_mfma_f32_32x32x8_bf16 v[36:51], v[148:149], v[28:29], v[36:51]
    v_cvt_pk_bf16_f32 v102, v56, v57
    v_cvt_pk_bf16_f32 v103, v58, v59
    v_exp_f32 v60, v60
    v_exp_f32 v61, v61
    v_exp_f32 v62, v62
    v_exp_f32 v63, v63
    v_mfma_f32_32x32x16_bf16 v[84:99], v[126:129], v[100:103], v[84:99]
    v_exp_f32 v64, v64
    v_exp_f32 v65, v65
    v_exp_f32 v66, v66
    v_exp_f32 v67, v67
    v_cvt_pk_bf16_f32 v104, v60, v61
    v_cvt_pk_bf16_f32 v105, v62, v63
    v_cvt_pk_bf16_f32 v106, v64, v65
    v_cvt_pk_bf16_f32 v107, v66, v67
    v_mfma_f32_32x32x16_bf16 v[52:67], v[136:139], v[30:33], 0
    v_exp_f32 v36, v36
    v_exp_f32 v37, v37
    v_exp_f32 v38, v38
    v_exp_f32 v39, v39
    v_mfma_f32_32x32x16_bf16 v[84:99], v[130:133], v[104:107], v[84:99]
    s_add_u32 s45, s45, 1
    s_and_b32 s45, s45, 7
    s_lshl_b32 s46, s45, 8
    buffer_load_dword v171, v170, s[8:11], s46 offen sc1
    buffer_load_dwordx4 v[122:125], v4, s[8:11], s32 offen
    buffer_load_dwordx2 v[134:135], v164, s[8:11], s32 offen offset:3072
    buffer_load_dwordx4 v[126:129], v216, s[8:11], s32 offen offset:1024
    buffer_load_dwordx4 v[130:133], v216, s[8:11], s32 offen offset:2048
    s_add_u32 s32, s32, 7168
    s_mov_b32 s44, s45
    v_exp_f32 v40, v40
    v_exp_f32 v41, v41
    v_exp_f32 v42, v42
    v_exp_f32 v43, v43
    v_cvt_pk_bf16_f32 v100, v36, v37
    v_cvt_pk_bf16_f32 v101, v38, v39
    v_mfma_f32_32x32x8_bf16 v[52:67], v[148:149], v[34:35], v[52:67]
    v_cvt_pk_bf16_f32 v102, v40, v41
    v_cvt_pk_bf16_f32 v103, v42, v43
    v_exp_f32 v44, v44
    v_exp_f32 v45, v45
    v_exp_f32 v46, v46
    v_exp_f32 v47, v47
    v_mfma_f32_32x32x16_bf16 v[68:83], v[140:143], v[100:103], v[68:83]
    v_exp_f32 v48, v48
    v_exp_f32 v49, v49
    v_exp_f32 v50, v50
    v_exp_f32 v51, v51
    v_cvt_pk_bf16_f32 v104, v44, v45
    v_cvt_pk_bf16_f32 v105, v46, v47
    v_cvt_pk_bf16_f32 v106, v48, v49
    v_cvt_pk_bf16_f32 v107, v50, v51
    s_waitcnt vmcnt(9)
    v_mfma_f32_32x32x16_bf16 v[36:51], v[150:153], v[24:27], 0
    v_exp_f32 v52, v52
    v_exp_f32 v53, v53
    v_exp_f32 v54, v54
    v_exp_f32 v55, v55
    v_mfma_f32_32x32x16_bf16 v[68:83], v[144:147], v[104:107], v[68:83]
    v_exp_f32 v56, v56
    v_exp_f32 v57, v57
    v_exp_f32 v58, v58
    v_exp_f32 v59, v59
    v_cvt_pk_bf16_f32 v100, v52, v53
    v_cvt_pk_bf16_f32 v101, v54, v55
    v_mfma_f32_32x32x8_bf16 v[36:51], v[162:163], v[28:29], v[36:51]
    v_cvt_pk_bf16_f32 v102, v56, v57
    v_cvt_pk_bf16_f32 v103, v58, v59
    v_exp_f32 v60, v60
    v_exp_f32 v61, v61
    v_exp_f32 v62, v62
    v_exp_f32 v63, v63
    v_mfma_f32_32x32x16_bf16 v[84:99], v[140:143], v[100:103], v[84:99]
    v_exp_f32 v64, v64
    v_exp_f32 v65, v65
    v_exp_f32 v66, v66
    v_exp_f32 v67, v67
    v_cvt_pk_bf16_f32 v104, v60, v61
    v_cvt_pk_bf16_f32 v105, v62, v63
    v_cvt_pk_bf16_f32 v106, v64, v65
    v_cvt_pk_bf16_f32 v107, v66, v67
    v_mfma_f32_32x32x16_bf16 v[52:67], v[150:153], v[30:33], 0
    v_exp_f32 v36, v36
    v_exp_f32 v37, v37
    v_exp_f32 v38, v38
    v_exp_f32 v39, v39
    v_mfma_f32_32x32x16_bf16 v[84:99], v[144:147], v[104:107], v[84:99]
    buffer_load_dwordx4 v[136:139], v4, s[8:11], s32 offen
    buffer_load_dwordx2 v[148:149], v164, s[8:11], s32 offen offset:3072
    buffer_load_dwordx4 v[140:143], v216, s[8:11], s32 offen offset:1024
    buffer_load_dwordx4 v[144:147], v216, s[8:11], s32 offen offset:2048
    s_add_u32 s32, s32, 7168
    v_exp_f32 v40, v40
    v_exp_f32 v41, v41
    v_exp_f32 v42, v42
    v_exp_f32 v43, v43
    v_cvt_pk_bf16_f32 v100, v36, v37
    v_cvt_pk_bf16_f32 v101, v38, v39
    v_mfma_f32_32x32x8_bf16 v[52:67], v[162:163], v[34:35], v[52:67]
    v_cvt_pk_bf16_f32 v102, v40, v41
    v_cvt_pk_bf16_f32 v103, v42, v43
    v_exp_f32 v44, v44
    v_exp_f32 v45, v45
    v_exp_f32 v46, v46
    v_exp_f32 v47, v47
    v_mfma_f32_32x32x16_bf16 v[68:83], v[154:157], v[100:103], v[68:83]
    v_exp_f32 v48, v48
    v_exp_f32 v49, v49
    v_exp_f32 v50, v50
    v_exp_f32 v51, v51
    v_cvt_pk_bf16_f32 v104, v44, v45
    v_cvt_pk_bf16_f32 v105, v46, v47
    v_cvt_pk_bf16_f32 v106, v48, v49
    v_cvt_pk_bf16_f32 v107, v50, v51
    s_waitcnt vmcnt(9)
    v_mfma_f32_32x32x16_bf16 v[36:51], v[108:111], v[24:27], 0
    v_exp_f32 v52, v52
    v_exp_f32 v53, v53
    v_exp_f32 v54, v54
    v_exp_f32 v55, v55
    v_mfma_f32_32x32x16_bf16 v[68:83], v[158:161], v[104:107], v[68:83]
    v_exp_f32 v56, v56
    v_exp_f32 v57, v57
    v_exp_f32 v58, v58
    v_exp_f32 v59, v59
    v_cvt_pk_bf16_f32 v100, v52, v53
    v_cvt_pk_bf16_f32 v101, v54, v55
    v_mfma_f32_32x32x8_bf16 v[36:51], v[120:121], v[28:29], v[36:51]
    v_cvt_pk_bf16_f32 v102, v56, v57
    v_cvt_pk_bf16_f32 v103, v58, v59
    v_exp_f32 v60, v60
    v_exp_f32 v61, v61
    v_exp_f32 v62, v62
    v_exp_f32 v63, v63
    v_mfma_f32_32x32x16_bf16 v[84:99], v[154:157], v[100:103], v[84:99]
    v_exp_f32 v64, v64
    v_exp_f32 v65, v65
    v_exp_f32 v66, v66
    v_exp_f32 v67, v67
    v_cvt_pk_bf16_f32 v104, v60, v61
    v_cvt_pk_bf16_f32 v105, v62, v63
    v_cvt_pk_bf16_f32 v106, v64, v65
    v_cvt_pk_bf16_f32 v107, v66, v67
    s_add_u32 s34, s34, 1
    s_cmp_lt_u32 s34, 4
    s_cbranch_scc1 interleave_layers__grouped_kv_mqa__mixer_channel_mlp__prompt_kernel_al49
    s_cmp_lg_u32 s12, 0
    s_cbranch_scc1 interleave_layers__grouped_kv_mqa__mixer_channel_mlp__prompt_kernel_nw53
    v_lshrrev_b32 v208, 1, v1
    v_lshlrev_b32 v208, 8, v208
    v_and_b32 v209, 1, v1
    v_lshl_add_u32 v208, v209, 4, v208
    s_mov_b32 s30, 0
interleave_layers__grouped_kv_mqa__mixer_channel_mlp__prompt_kernel_lw54:
    buffer_load_dwordx4 v[212:215], v208, s[8:11], 0 offen offset:0 sc1
    s_waitcnt vmcnt(0)
    v_subrev_u32 v212, s38, v212
    v_subrev_u32 v213, s38, v213
    v_subrev_u32 v214, s38, v214
    v_subrev_u32 v215, s38, v215
    v_max_u32 v212, v212, v213
    v_max_u32 v214, v214, v215
    v_max_u32 v212, v212, v214
    v_cmp_le_u32 vcc, 32, v212
    s_cbranch_vccz interleave_layers__grouped_kv_mqa__mixer_channel_mlp__prompt_kernel_lwd55
    s_add_u32 s30, s30, 1
    s_cmp_lt_u32 s30, 0x40000
    s_cbranch_scc1 interleave_layers__grouped_kv_mqa__mixer_channel_mlp__prompt_kernel_lw54
interleave_layers__grouped_kv_mqa__mixer_channel_mlp__prompt_kernel_lwd55:
interleave_layers__grouped_kv_mqa__mixer_channel_mlp__prompt_kernel_nw53:
    s_lshl_b32 s35, s3, 10
    s_mul_i32 s36, s7, 102400
    s_add_u32 s36, s36, 32702464
interleave_layers__grouped_kv_mqa__mixer_channel_mlp__prompt_kernel_bl56:
    v_mfma_f32_32x32x16_bf16 v[52:67], v[108:111], v[30:33], 0
    v_exp_f32 v36, v36
    v_exp_f32 v37, v37
    v_exp_f32 v38, v38
    v_exp_f32 v39, v39
    v_mfma_f32_32x32x16_bf16 v[84:99], v[158:161], v[104:107], v[84:99]
    s_min_u32 m0, s35, 101376
    s_add_u32 s37, s36, m0
    buffer_load_dwordx4 v4, s[8:11], s37 offen sc1 lds
    s_add_u32 s35, s35, 8192
    buffer_load_dwordx4 v[150:153], v4, s[8:11], s32 offen
    buffer_load_dwordx2 v[162:163], v164, s[8:11], s32 offen offset:3072
    buffer_load_dwordx4 v[154:157], v216, s[8:11], s32 offen offset:1024
    buffer_load_dwordx4 v[158:161], v216, s[8:11], s32 offen offset:2048
    s_add_u32 s32, s32, 7168
    v_exp_f32 v40, v40
    v_exp_f32 v41, v41
    v_exp_f32 v42, v42
    v_exp_f32 v43, v43
    v_cvt_pk_bf16_f32 v100, v36, v37
    v_cvt_pk_bf16_f32 v101, v38, v39
    v_mfma_f32_32x32x8_bf16 v[52:67], v[120:121], v[34:35], v[52:67]
    v_cvt_pk_bf16_f32 v102, v40, v41
    v_cvt_pk_bf16_f32 v103, v42, v43
    v_exp_f32 v44, v44
    v_exp_f32 v45, v45
    v_exp_f32 v46, v46
    v_exp_f32 v47, v47
    v_mfma_f32_32x32x16_bf16 v[68:83], v[112:115], v[100:103], v[68:83]
    v_exp_f32 v48, v48
    v_exp_f32 v49, v49
    v_exp_f32 v50, v50
    v_exp_f32 v51, v51
    v_cvt_pk_bf16_f32 v104, v44, v45
    v_cvt_pk_bf16_f32 v105, v46, v47
    v_cvt_pk_bf16_f32 v106, v48, v49
    v_cvt_pk_bf16_f32 v107, v50, v51
    s_waitcnt vmcnt(9)
    v_mfma_f32_32x32x16_bf16 v[36:51], v[122:125], v[24:27], 0
    v_exp_f32 v52, v52
    v_exp_f32 v53, v53
    v_exp_f32 v54, v54
    v_exp_f32 v55, v55
    v_mfma_f32_32x32x16_bf16 v[68:83], v[116:119], v[104:107], v[68:83]
    v_exp_f32 v56, v56
    v_exp_f32 v57, v57
    v_exp_f32 v58, v58
    v_exp_f32 v59, v59
    v_cvt_pk_bf16_f32 v100, v52, v53
    v_cvt_pk_bf16_f32 v101, v54, v55
    v_mfma_f32_32x32x8_bf16 v[36:51], v[134:135], v[28:29], v[36:51]
    v_cvt_pk_bf16_f32 v102, v56, v57
    v_cvt_pk_bf16_f32 v103, v58, v59
    v_exp_f32 v60, v60
    v_exp_f32 v61, v61
    v_exp_f32 v62, v62
    v_exp_f32 v63, v63
    v_mfma_f32_32x32x16_bf16 v[84:99], v[112:115], v[100:103], v[84:99]
    v_exp_f32 v64, v64
    v_exp_f32 v65, v65
    v_exp_f32 v66, v66
    v_exp_f32 v67, v67
    v_cvt_pk_bf16_f32 v104, v60, v61
    v_cvt_pk_bf16_f32 v105, v62, v63
    v_cvt_pk_bf16_f32 v106, v64, v65
    v_cvt_pk_bf16_f32 v107, v66, v67
    v_mfma_f32_32x32x16_bf16 v[52:67], v[122:125], v[30:33], 0
    v_exp_f32 v36, v36
    v_exp_f32 v37, v37
    v_exp_f32 v38, v38
    v_exp_f32 v39, v39
    v_mfma_f32_32x32x16_bf16 v[84:99], v[116:119], v[104:107], v[84:99]
    v_subrev_u32 v171, s38, v171
    v_cmp_le_u32 vcc, 32, v171
    s_cbranch_vccz interleave_layers__grouped_kv_mqa__mixer_channel_mlp__prompt_kernel_fok57
    s_lshl_b32 s28, s44, 8
    s_mov_b32 s30, 0
interleave_layers__grouped_kv_mqa__mixer_channel_mlp__prompt_kernel_sg58:
    buffer_load_dword v171, v170, s[8:11], s28 offen sc1
    s_waitcnt vmcnt(0)
    v_subrev_u32 v171, s38, v171
    v_cmp_le_u32 vcc, 32, v171
    s_cbranch_vccz interleave_layers__grouped_kv_mqa__mixer_channel_mlp__prompt_kernel_sgd59
    s_sleep 2
    s_add_u32 s30, s30, 1
    s_cmp_lt_u32 s30, 0x40000
    s_cbranch_scc1 interleave_layers__grouped_kv_mqa__mixer_channel_mlp__prompt_kernel_sg58
interleave_layers__grouped_kv_mqa__mixer_channel_mlp__prompt_kernel_sgd59:
interleave_layers__grouped_kv_mqa__mixer_channel_mlp__prompt_kernel_fok57:
    s_cmp_ge_u32 s32, s33
    s_cselect_b32 s28, 229376, 0
    s_sub_u32 s32, s32, s28
    s_min_u32 m0, s35, 101376
    s_add_u32 s37, s36, m0
    buffer_load_dwordx4 v4, s[8:11], s37 offen sc1 lds
    s_add_u32 s35, s35, 8192
    buffer_load_dwordx4 v[108:111], v4, s[8:11], s32 offen
    buffer_load_dwordx2 v[120:121], v164, s[8:11], s32 offen offset:3072
    buffer_load_dwordx4 v[112:115], v216, s[8:11], s32 offen offset:1024
    buffer_load_dwordx4 v[116:119], v216, s[8:11], s32 offen offset:2048
    s_add_u32 s32, s32, 7168
    v_exp_f32 v40, v40
    v_exp_f32 v41, v41
    v_exp_f32 v42, v42
    v_exp_f32 v43, v43
    v_cvt_pk_bf16_f32 v100, v36, v37
    v_cvt_pk_bf16_f32 v101, v38, v39
    v_mfma_f32_32x32x8_bf16 v[52:67], v[134:135], v[34:35], v[52:67]
    v_cvt_pk_bf16_f32 v102, v40, v41
    v_cvt_pk_bf16_f32 v103, v42, v43
    v_exp_f32 v44, v44
    v_exp_f32 v45, v45
    v_exp_f32 v46, v46
    v_exp_f32 v47, v47
    v_mfma_f32_32x32x16_bf16 v[68:83], v[126:129], v[100:103], v[68:83]
    v_exp_f32 v48, v48
    v_exp_f32 v49, v49
    v_exp_f32 v50, v50
    v_exp_f32 v51, v51
    v_cvt_pk_bf16_f32 v104, v44, v45
    v_cvt_pk_bf16_f32 v105, v46, v47
    v_cvt_pk_bf16_f32 v106, v48, v49
    v_cvt_pk_bf16_f32 v107, v50, v51
    s_waitcnt vmcnt(10)
    v_mfma_f32_32x32x16_bf16 v[36:51], v[136:139], v[24:27], 0
    v_exp_f32 v52, v52
    v_exp_f32 v53, v53
    v_exp_f32 v54, v54
    v_exp_f32 v55, v55
    v_mfma_f32_32x32x16_bf16 v[68:83], v[130:133], v[104:107], v[68:83]
    v_exp_f32 v56, v56
    v_exp_f32 v57, v57
    v_exp_f32 v58, v58
    v_exp_f32 v59, v59
    v_cvt_pk_bf16_f32 v100, v52, v53
    v_cvt_pk_bf16_f32 v101, v54, v55
    v_mfma_f32_32x32x8_bf16 v[36:51], v[148:149], v[28:29], v[36:51]
    v_cvt_pk_bf16_f32 v102, v56, v57
    v_cvt_pk_bf16_f32 v103, v58, v59
    v_exp_f32 v60, v60
    v_exp_f32 v61, v61
    v_exp_f32 v62, v62
    v_exp_f32 v63, v63
    v_mfma_f32_32x32x16_bf16 v[84:99], v[126:129], v[100:103], v[84:99]
    v_exp_f32 v64, v64
    v_exp_f32 v65, v65
    v_exp_f32 v66, v66
    v_exp_f32 v67, v67
    v_cvt_pk_bf16_f32 v104, v60, v61
    v_cvt_pk_bf16_f32 v105, v62, v63
    v_cvt_pk_bf16_f32 v106, v64, v65
    v_cvt_pk_bf16_f32 v107, v66, v67
    v_mfma_f32_32x32x16_bf16 v[52:67], v[136:139], v[30:33], 0
    v_exp_f32 v36, v36
    v_exp_f32 v37, v37
    v_exp_f32 v38, v38
    v_exp_f32 v39, v39
    v_mfma_f32_32x32x16_bf16 v[84:99], v[130:133], v[104:107], v[84:99]
    s_add_u32 s45, s45, 1
    s_and_b32 s45, s45, 7
    s_lshl_b32 s46, s45, 8
    buffer_load_dword v171, v170, s[8:11], s46 offen sc1
    s_min_u32 m0, s35, 101376
    s_add_u32 s37, s36, m0
    buffer_load_dwordx4 v4, s[8:11], s37 offen sc1 lds
    s_add_u32 s35, s35, 8192
    buffer_load_dwordx4 v[122:125], v4, s[8:11], s32 offen
    buffer_load_dwordx2 v[134:135], v164, s[8:11], s32 offen offset:3072
    buffer_load_dwordx4 v[126:129], v216, s[8:11], s32 offen offset:1024
    buffer_load_dwordx4 v[130:133], v216, s[8:11], s32 offen offset:2048
    s_add_u32 s32, s32, 7168
    s_mov_b32 s44, s45
    v_exp_f32 v40, v40
    v_exp_f32 v41, v41
    v_exp_f32 v42, v42
    v_exp_f32 v43, v43
    v_cvt_pk_bf16_f32 v100, v36, v37
    v_cvt_pk_bf16_f32 v101, v38, v39
    v_mfma_f32_32x32x8_bf16 v[52:67], v[148:149], v[34:35], v[52:67]
    v_cvt_pk_bf16_f32 v102, v40, v41
    v_cvt_pk_bf16_f32 v103, v42, v43
    v_exp_f32 v44, v44
    v_exp_f32 v45, v45
    v_exp_f32 v46, v46
    v_exp_f32 v47, v47
    v_mfma_f32_32x32x16_bf16 v[68:83], v[140:143], v[100:103], v[68:83]
    v_exp_f32 v48, v48
    v_exp_f32 v49, v49
    v_exp_f32 v50, v50
    v_exp_f32 v51, v51
    v_cvt_pk_bf16_f32 v104, v44, v45
    v_cvt_pk_bf16_f32 v105, v46, v47
    v_cvt_pk_bf16_f32 v106, v48, v49
    v_cvt_pk_bf16_f32 v107, v50, v51
    s_waitcnt vmcnt(11)
    v_mfma_f32_32x32x16_bf16 v[36:51], v[150:153], v[24:27], 0
    v_exp_f32 v52, v52
    v_exp_f32 v53, v53
    v_exp_f32 v54, v54
    v_exp_f32 v55, v55
    v_mfma_f32_32x32x16_bf16 v[68:83], v[144:147], v[104:107], v[68:83]
    v_exp_f32 v56, v56
    v_exp_f32 v57, v57
    v_exp_f32 v58, v58
    v_exp_f32 v59, v59
    v_cvt_pk_bf16_f32 v100, v52, v53
    v_cvt_pk_bf16_f32 v101, v54, v55
    v_mfma_f32_32x32x8_bf16 v[36:51], v[162:163], v[28:29], v[36:51]
    v_cvt_pk_bf16_f32 v102, v56, v57
    v_cvt_pk_bf16_f32 v103, v58, v59
    v_exp_f32 v60, v60
    v_exp_f32 v61, v61
    v_exp_f32 v62, v62
    v_exp_f32 v63, v63
    v_mfma_f32_32x32x16_bf16 v[84:99], v[140:143], v[100:103], v[84:99]
    v_exp_f32 v64, v64
    v_exp_f32 v65, v65
    v_exp_f32 v66, v66
    v_exp_f32 v67, v67
    v_cvt_pk_bf16_f32 v104, v60, v61
    v_cvt_pk_bf16_f32 v105, v62, v63
    v_cvt_pk_bf16_f32 v106, v64, v65
    v_cvt_pk_bf16_f32 v107, v66, v67
    v_mfma_f32_32x32x16_bf16 v[52:67], v[150:153], v[30:33], 0
    v_exp_f32 v36, v36
    v_exp_f32 v37, v37
    v_exp_f32 v38, v38
    v_exp_f32 v39, v39
    v_mfma_f32_32x32x16_bf16 v[84:99], v[144:147], v[104:107], v[84:99]
    s_min_u32 m0, s35, 101376
    s_add_u32 s37, s36, m0
    buffer_load_dwordx4 v4, s[8:11], s37 offen sc1 lds
    s_add_u32 s35, s35, 8192
    buffer_load_dwordx4 v[136:139], v4, s[8:11], s32 offen
    buffer_load_dwordx2 v[148:149], v164, s[8:11], s32 offen offset:3072
    buffer_load_dwordx4 v[140:143], v216, s[8:11], s32 offen offset:1024
    buffer_load_dwordx4 v[144:147], v216, s[8:11], s32 offen offset:2048
    s_add_u32 s32, s32, 7168
    v_exp_f32 v40, v40
    v_exp_f32 v41, v41
    v_exp_f32 v42, v42
    v_exp_f32 v43, v43
    v_cvt_pk_bf16_f32 v100, v36, v37
    v_cvt_pk_bf16_f32 v101, v38, v39
    v_mfma_f32_32x32x8_bf16 v[52:67], v[162:163], v[34:35], v[52:67]
    v_cvt_pk_bf16_f32 v102, v40, v41
    v_cvt_pk_bf16_f32 v103, v42, v43
    v_exp_f32 v44, v44
    v_exp_f32 v45, v45
    v_exp_f32 v46, v46
    v_exp_f32 v47, v47
    v_mfma_f32_32x32x16_bf16 v[68:83], v[154:157], v[100:103], v[68:83]
    v_exp_f32 v48, v48
    v_exp_f32 v49, v49
    v_exp_f32 v50, v50
    v_exp_f32 v51, v51
    v_cvt_pk_bf16_f32 v104, v44, v45
    v_cvt_pk_bf16_f32 v105, v46, v47
    v_cvt_pk_bf16_f32 v106, v48, v49
    v_cvt_pk_bf16_f32 v107, v50, v51
    s_waitcnt vmcnt(11)
    v_mfma_f32_32x32x16_bf16 v[36:51], v[108:111], v[24:27], 0
    v_exp_f32 v52, v52
    v_exp_f32 v53, v53
    v_exp_f32 v54, v54
    v_exp_f32 v55, v55
    v_mfma_f32_32x32x16_bf16 v[68:83], v[158:161], v[104:107], v[68:83]
    v_exp_f32 v56, v56
    v_exp_f32 v57, v57
    v_exp_f32 v58, v58
    v_exp_f32 v59, v59
    v_cvt_pk_bf16_f32 v100, v52, v53
    v_cvt_pk_bf16_f32 v101, v54, v55
    v_mfma_f32_32x32x8_bf16 v[36:51], v[120:121], v[28:29], v[36:51]
    v_cvt_pk_bf16_f32 v102, v56, v57
    v_cvt_pk_bf16_f32 v103, v58, v59
    v_exp_f32 v60, v60
    v_exp_f32 v61, v61
    v_exp_f32 v62, v62
    v_exp_f32 v63, v63
    v_mfma_f32_32x32x16_bf16 v[84:99], v[154:157], v[100:103], v[84:99]
    v_exp_f32 v64, v64
    v_exp_f32 v65, v65
    v_exp_f32 v66, v66
    v_exp_f32 v67, v67
    v_cvt_pk_bf16_f32 v104, v60, v61
    v_cvt_pk_bf16_f32 v105, v62, v63
    v_cvt_pk_bf16_f32 v106, v64, v65
    v_cvt_pk_bf16_f32 v107, v66, v67
    s_add_u32 s34, s34, 1
    s_cmp_lt_u32 s34, 8
    s_cbranch_scc1 interleave_layers__grouped_kv_mqa__mixer_channel_mlp__prompt_kernel_bl56
    v_mfma_f32_32x32x16_bf16 v[84:99], v[158:161], v[104:107], v[84:99]
    s_waitcnt vmcnt(0)
interleave_layers__grouped_kv_mqa__mixer_channel_mlp__prompt_kernel_combine60:
    s_nop 7
    s_nop 7
    s_mul_i32 s28, s3, 3072
    s_add_u32 s28, s28, 112640
    v_add_u32 v165, s28, v4
    s_xor_b32 s29, s3, 4
    s_mul_i32 s29, s29, 3072
    s_add_u32 s29, s29, 112640
    v_add_u32 v166, s29, v4
    s_cmp_eq_u32 s5, 1
    s_cbranch_scc1 interleave_layers__grouped_kv_mqa__mixer_channel_mlp__prompt_kernel_c162
    ds_write_b128 v165, v[84:87] offset:0
    ds_write_b128 v165, v[88:91] offset:1024
    ds_write_b128 v165, v[92:95] offset:2048
    s_branch interleave_layers__grouped_kv_mqa__mixer_channel_mlp__prompt_kernel_c263
interleave_layers__grouped_kv_mqa__mixer_channel_mlp__prompt_kernel_c162:
    ds_write_b128 v165, v[68:71] offset:0
    ds_write_b128 v165, v[72:75] offset:1024
    ds_write_b128 v165, v[76:79] offset:2048
    v_mov_b32 v68, v84
    v_mov_b32 v69, v85
    v_mov_b32 v70, v86
    v_mov_b32 v71, v87
    v_mov_b32 v72, v88
    v_mov_b32 v73, v89
    v_mov_b32 v74, v90
    v_mov_b32 v75, v91
    v_mov_b32 v76, v92
    v_mov_b32 v77, v93
    v_mov_b32 v78, v94
    v_mov_b32 v79, v95
interleave_layers__grouped_kv_mqa__mixer_channel_mlp__prompt_kernel_c263:
    s_waitcnt lgkmcnt(0)
    s_barrier
    ds_read_b128 v[52:55], v166 offset:0
    ds_read_b128 v[56:59], v166 offset:1024
    ds_read_b128 v[60:63], v166 offset:2048
    s_waitcnt lgkmcnt(0)
    v_add_f32 v68, v68, v52
    v_add_f32 v69, v69, v53
    v_add_f32 v70, v70, v54
    v_add_f32 v71, v71, v55
    v_add_f32 v72, v72, v56
    v_add_f32 v73, v73, v57
    v_add_f32 v74, v74, v58
    v_add_f32 v75, v75, v59
    v_add_f32 v76, v76, v60
    v_add_f32 v77, v77, v61
    v_add_f32 v78, v78, v62
    v_add_f32 v79, v79, v63
    v_mov_b32 v167, v76
    v_mov_b32 v168, v76
    s_nop 1
    v_permlane32_swap_b32 v167, v168
    v_add_f32 v167, abs(v68), abs(v69)
    v_add_f32 v167, abs(v70), v167
    v_add_f32 v167, abs(v71), v167
    v_add_f32 v167, abs(v72), v167
    v_add_f32 v167, abs(v73), v167
    v_add_f32 v167, abs(v74), v167
    v_add_f32 v167, abs(v75), v167
    v_add_f32 v167, abs(v76), v167
    v_add_f32 v167, abs(v77), v167
    v_add_f32 v167, abs(v78), v167
    v_add_f32 v167, abs(v79), v167
    s_mov_b32 s28, 0x30800000
    s_mov_b32 s29, 0x5d800000
    s_mov_b32 s30, 0x7b800000
    v_cmp_nle_f32 s[44:45], s28, v168
    v_cmp_nge_f32 s[46:47], s29, v168
    v_cmp_ngt_f32 vcc, s30, v167
    s_or_b64 s[44:45], s[44:45], s[46:47]
    s_or_b64 vcc, vcc, s[44:45]
    s_cbranch_vccz interleave_layers__grouped_kv_mqa__mixer_channel_mlp__prompt_kernel_okl64
    v_mov_b32 v172, 163780
    v_mov_b32 v173, 1
    ds_write_b32 v172, v173
interleave_layers__grouped_kv_mqa__mixer_channel_mlp__prompt_kernel_okl64:
    v_rcp_f32 v168, v168
    s_nop 0
    v_mul_f32 v68, v68, v168
    v_mul_f32 v69, v69, v168
    v_mul_f32 v70, v70, v168
    v_mul_f32 v71, v71, v168
    v_mul_f32 v72, v72, v168
    v_mul_f32 v73, v73, v168
    v_mul_f32 v74, v74, v168
    v_mul_f32 v75, v75, v168
    v_mul_f32 v76, v76, v168
    v_mul_f32 v77, v77, v168
    v_mul_f32 v78, v78, v168
    v_mul_f32 v79, v79, v168
    v_cvt_pk_bf16_f32 v36, v68, v69
    v_cvt_pk_bf16_f32 v37, v70, v71
    v_cvt_pk_bf16_f32 v38, v72, v73
    v_cvt_pk_bf16_f32 v39, v74, v75
    v_cvt_pk_bf16_f32 v40, v76, v77
    v_cvt_pk_bf16_f32 v41, v78, v79
    s_mul_i32 s28, s4, 5
    v_add_u32 v169, s28, v6
    v_lshrrev_b32 v170, 4, v5
    s_lshl_b32 s29, s5, 1
    v_add_u32 v170, s29, v170
    v_mul_u32_u24 v170, 2560, v170
    v_lshl_add_u32 v170, v2, 4, v170
    v_add_u32 v170, 137216, v170
    v_mov_b32 v171, v169
    v_lshrrev_b32 v172, 1, v171
    v_lshlrev_b32 v172, 8, v172
    v_and_b32 v173, 1, v171
    v_lshl_add_u32 v172, v173, 3, v172
    v_add_u32 v172, v172, v170
    ds_write_b64 v172, v[36:37]
    v_add_u32 v171, 2, v169
    v_lshrrev_b32 v172, 1, v171
    v_lshlrev_b32 v172, 8, v172
    v_and_b32 v173, 1, v171
    v_lshl_add_u32 v172, v173, 3, v172
    v_add_u32 v172, v172, v170
    ds_write_b64 v172, v[38:39]
    v_mov_b32 v171, s28
    v_add_u32 v171, 4, v171
    v_lshrrev_b32 v172, 1, v171
    v_lshlrev_b32 v172, 8, v172
    v_and_b32 v173, 1, v171
    v_lshl_add_u32 v172, v173, 3, v172
    v_add_u32 v172, v172, v170
    s_mov_b32 exec_hi, 0
    ds_write_b64 v172, v[40:41]
    s_mov_b64 exec, -1
    s_waitcnt lgkmcnt(0)
    s_barrier
    v_mov_b32 v172, 163780
    ds_read_b32 v173, v172
    s_waitcnt lgkmcnt(0)
    v_readfirstlane_b32 s28, v173
    s_lshl_b32 s29, s49, 1
    s_cmp_gt_u32 s28, s29
    s_cbranch_scc1 interleave_layers__grouped_kv_mqa__mixer_channel_mlp__prompt_kernel_fallback61
    s_mul_i32 s31, s12, 2621440
    s_add_u32 s31, s31, 491520
    s_mul_i32 s28, s6, 81920
    s_add_u32 s31, s31, s28
    s_mul_i32 s28, s7, 2560
    s_add_u32 s31, s31, s28
    s_lshl_b32 s28, s3, 6
    s_add_u32 s28, s28, 0
    v_add_u32 v169, s28, v1
    v_lshlrev_b32 v170, 4, v169
    v_add_u32 v170, 137216, v170
    ds_read_b128 v[36:39], v170
    v_mul_u32_u24 v171, 410, v169
    v_lshrrev_b32 v171, 16, v171
    v_mul_u32_u24 v172, 160, v171
    v_sub_u32 v172, v169, v172
    v_mul_u32_u24 v171, 20480, v171
    v_lshl_add_u32 v171, v172, 4, v171
    s_waitcnt lgkmcnt(0)
    buffer_store_dwordx4 v[36:39], v171, s[8:11], s31 offen sc1
interleave_layers__grouped_kv_mqa__mixer_channel_mlp__prompt_kernel_oc65:
    s_cmp_ge_u32 s3, 2
    s_cbranch_scc1 interleave_layers__grouped_kv_mqa__mixer_channel_mlp__prompt_kernel_oc66
    s_lshl_b32 s28, s3, 6
    s_add_u32 s28, s28, 512
    v_add_u32 v169, s28, v1
    v_lshlrev_b32 v170, 4, v169
    v_add_u32 v170, 137216, v170
    ds_read_b128 v[36:39], v170
    v_mul_u32_u24 v171, 410, v169
    v_lshrrev_b32 v171, 16, v171
    v_mul_u32_u24 v172, 160, v171
    v_sub_u32 v172, v169, v172
    v_mul_u32_u24 v171, 20480, v171
    v_lshl_add_u32 v171, v172, 4, v171
    s_waitcnt lgkmcnt(0)
    buffer_store_dwordx4 v[36:39], v171, s[8:11], s31 offen sc1
interleave_layers__grouped_kv_mqa__mixer_channel_mlp__prompt_kernel_oc66:
    s_waitcnt vmcnt(0)
    s_barrier
    s_cmp_lg_u32 s3, 0
    s_cbranch_scc1 interleave_layers__grouped_kv_mqa__mixer_channel_mlp__prompt_kernel_pub67
    s_add_u32 s28, s13, 2
    v_mov_b32 v22, s28
    s_lshl_b32 s29, s6, 8
    s_lshl_b32 s30, s7, 2
    s_add_u32 s29, s29, s30
    v_mov_b32 v21, s29
    s_mov_b64 exec, 1
    buffer_store_dword v22, v21, s[8:11], 0 offen offset:0 sc1
    s_mov_b64 exec, -1
interleave_layers__grouped_kv_mqa__mixer_channel_mlp__prompt_kernel_pub67:
    s_branch interleave_layers__grouped_kv_mqa__mixer_channel_mlp__prompt_kernel_after68
interleave_layers__grouped_kv_mqa__mixer_channel_mlp__prompt_kernel_fallback61:
    s_barrier
    v_mov_b32 v174, 0xff800000
    v_mov_b32 v175, 0xff800000
    s_mul_i32 s32, s12, 229376
    s_add_u32 s32, s32, 32768
    s_mul_i32 s28, s5, 3584
    s_add_u32 s32, s32, s28
    s_mov_b32 s34, 0
interleave_layers__grouped_kv_mqa__mixer_channel_mlp__prompt_kernel_fb169:
    buffer_load_dwordx4 v[108:111], v4, s[8:11], s32 offen
    buffer_load_dwordx2 v[120:121], v164, s[8:11], s32 offen offset:3072
    buffer_load_dwordx4 v[112:115], v216, s[8:11], s32 offen offset:1024
    buffer_load_dwordx4 v[116:119], v216, s[8:11], s32 offen offset:2048
    s_add_u32 s32, s32, 7168
    s_waitcnt vmcnt(0)
    v_mfma_f32_32x32x16_bf16 v[36:51], v[108:111], v[24:27], 0
    v_mfma_f32_32x32x8_bf16 v[36:51], v[120:121], v[28:29], v[36:51]
    v_mfma_f32_32x32x16_bf16 v[52:67], v[108:111], v[30:33], 0
    v_mfma_f32_32x32x8_bf16 v[52:67], v[120:121], v[34:35], v[52:67]
    s_nop 9
    v_max3_f32 v174, v36, v37, v174
    v_max3_f32 v174, v38, v39, v174
    v_max3_f32 v174, v40, v41, v174
    v_max3_f32 v174, v42, v43, v174
    v_max3_f32 v174, v44, v45, v174
    v_max3_f32 v174, v46, v47, v174
    v_max3_f32 v174, v48, v49, v174
    v_max3_f32 v174, v50, v51, v174
    v_max3_f32 v175, v52, v53, v175
    v_max3_f32 v175, v54, v55, v175
    v_max3_f32 v175, v56, v57, v175
    v_max3_f32 v175, v58, v59, v175
    v_max3_f32 v175, v60, v61, v175
    v_max3_f32 v175, v62, v63, v175
    v_max3_f32 v175, v64, v65, v175
    v_max3_f32 v175, v66, v67, v175
    s_add_u32 s34, s34, 1
    s_cmp_lt_u32 s34, 32
    s_cbranch_scc1 interleave_layers__grouped_kv_mqa__mixer_channel_mlp__prompt_kernel_fb169
    v_mov_b32 v176, v174
    s_nop 1
    v_permlane32_swap_b32 v174, v176
    v_max_f32 v174, v174, v176
    v_mov_b32 v176, v175
    s_nop 1
    v_permlane32_swap_b32 v175, v176
    v_max_f32 v175, v175, v176
    s_lshl_b32 s28, s3, 9
    s_add_u32 s28, s28, 112640
    v_lshl_add_u32 v176, v1, 3, s28
    ds_write_b64 v176, v[174:175]
    s_waitcnt lgkmcnt(0)
    s_barrier
    s_xor_b32 s28, s3, 4
    s_lshl_b32 s28, s28, 9
    s_add_u32 s28, s28, 112640
    v_lshl_add_u32 v176, v1, 3, s28
    ds_read_b64 v[178:179], v176
    s_waitcnt lgkmcnt(0)
    s_barrier
    v_max_f32 v174, v174, v178
    v_max_f32 v175, v175, v179
    v_sub_f32 v176, 0, v174
    v_sub_f32 v177, 0, v174
    v_sub_f32 v178, 0, v174
    v_sub_f32 v179, 0, v174
    v_sub_f32 v180, 0, v174
    v_sub_f32 v181, 0, v174
    v_sub_f32 v182, 0, v174
    v_sub_f32 v183, 0, v174
    v_sub_f32 v184, 0, v174
    v_sub_f32 v185, 0, v174
    v_sub_f32 v186, 0, v174
    v_sub_f32 v187, 0, v174
    v_sub_f32 v188, 0, v174
    v_sub_f32 v189, 0, v174
    v_sub_f32 v190, 0, v174
    v_sub_f32 v191, 0, v174
    v_mov_b32 v68, 0
    v_mov_b32 v69, 0
    v_mov_b32 v70, 0
    v_mov_b32 v71, 0
    v_mov_b32 v72, 0
    v_mov_b32 v73, 0
    v_mov_b32 v74, 0
    v_mov_b32 v75, 0
    v_mov_b32 v76, 0
    v_mov_b32 v77, 0
    v_mov_b32 v78, 0
    v_mov_b32 v79, 0
    v_mov_b32 v80, 0
    v_mov_b32 v81, 0
    v_mov_b32 v82, 0
    v_mov_b32 v83, 0
    v_sub_f32 v192, 0, v175
    v_sub_f32 v193, 0, v175
    v_sub_f32 v194, 0, v175
    v_sub_f32 v195, 0, v175
    v_sub_f32 v196, 0, v175
    v_sub_f32 v197, 0, v175
    v_sub_f32 v198, 0, v175
    v_sub_f32 v199, 0, v175
    v_sub_f32 v200, 0, v175
    v_sub_f32 v201, 0, v175
    v_sub_f32 v202, 0, v175
    v_sub_f32 v203, 0, v175
    v_sub_f32 v204, 0, v175
    v_sub_f32 v205, 0, v175
    v_sub_f32 v206, 0, v175
    v_sub_f32 v207, 0, v175
    v_mov_b32 v84, 0
    v_mov_b32 v85, 0
    v_mov_b32 v86, 0
    v_mov_b32 v87, 0
    v_mov_b32 v88, 0
    v_mov_b32 v89, 0
    v_mov_b32 v90, 0
    v_mov_b32 v91, 0
    v_mov_b32 v92, 0
    v_mov_b32 v93, 0
    v_mov_b32 v94, 0
    v_mov_b32 v95, 0
    v_mov_b32 v96, 0
    v_mov_b32 v97, 0
    v_mov_b32 v98, 0
    v_mov_b32 v99, 0
    s_mul_i32 s32, s12, 229376
    s_add_u32 s32, s32, 32768
    s_mul_i32 s28, s5, 3584
    s_add_u32 s32, s32, s28
    s_mov_b32 s34, 0
interleave_layers__grouped_kv_mqa__mixer_channel_mlp__prompt_kernel_fb270:
    buffer_load_dwordx4 v[108:111], v4, s[8:11], s32 offen
    buffer_load_dwordx2 v[120:121], v164, s[8:11], s32 offen offset:3072
    buffer_load_dwordx4 v[112:115], v216, s[8:11], s32 offen offset:1024
    buffer_load_dwordx4 v[116:119], v216, s[8:11], s32 offen offset:2048
    s_add_u32 s32, s32, 7168
    s_waitcnt vmcnt(0)
    v_mfma_f32_32x32x16_bf16 v[36:51], v[108:111], v[24:27], v[176:191]
    v_mfma_f32_32x32x8_bf16 v[36:51], v[120:121], v[28:29], v[36:51]
    s_nop 11
    v_exp_f32 v36, v36
    v_exp_f32 v37, v37
    v_exp_f32 v38, v38
    v_exp_f32 v39, v39
    v_exp_f32 v40, v40
    v_exp_f32 v41, v41
    v_exp_f32 v42, v42
    v_exp_f32 v43, v43
    v_exp_f32 v44, v44
    v_exp_f32 v45, v45
    v_exp_f32 v46, v46
    v_exp_f32 v47, v47
    v_exp_f32 v48, v48
    v_exp_f32 v49, v49
    v_exp_f32 v50, v50
    v_exp_f32 v51, v51
    v_cvt_pk_bf16_f32 v100, v36, v37
    v_cvt_pk_bf16_f32 v101, v38, v39
    v_cvt_pk_bf16_f32 v102, v40, v41
    v_cvt_pk_bf16_f32 v103, v42, v43
    v_cvt_pk_bf16_f32 v104, v44, v45
    v_cvt_pk_bf16_f32 v105, v46, v47
    v_cvt_pk_bf16_f32 v106, v48, v49
    v_cvt_pk_bf16_f32 v107, v50, v51
    v_mfma_f32_32x32x16_bf16 v[68:83], v[112:115], v[100:103], v[68:83]
    s_nop 0
    v_mfma_f32_32x32x16_bf16 v[68:83], v[116:119], v[104:107], v[68:83]
    v_mfma_f32_32x32x16_bf16 v[52:67], v[108:111], v[30:33], v[192:207]
    v_mfma_f32_32x32x8_bf16 v[52:67], v[120:121], v[34:35], v[52:67]
    s_nop 11
    v_exp_f32 v52, v52
    v_exp_f32 v53, v53
    v_exp_f32 v54, v54
    v_exp_f32 v55, v55
    v_exp_f32 v56, v56
    v_exp_f32 v57, v57
    v_exp_f32 v58, v58
    v_exp_f32 v59, v59
    v_exp_f32 v60, v60
    v_exp_f32 v61, v61
    v_exp_f32 v62, v62
    v_exp_f32 v63, v63
    v_exp_f32 v64, v64
    v_exp_f32 v65, v65
    v_exp_f32 v66, v66
    v_exp_f32 v67, v67
    v_cvt_pk_bf16_f32 v100, v52, v53
    v_cvt_pk_bf16_f32 v101, v54, v55
    v_cvt_pk_bf16_f32 v102, v56, v57
    v_cvt_pk_bf16_f32 v103, v58, v59
    v_cvt_pk_bf16_f32 v104, v60, v61
    v_cvt_pk_bf16_f32 v105, v62, v63
    v_cvt_pk_bf16_f32 v106, v64, v65
    v_cvt_pk_bf16_f32 v107, v66, v67
    v_mfma_f32_32x32x16_bf16 v[84:99], v[112:115], v[100:103], v[84:99]
    s_nop 0
    v_mfma_f32_32x32x16_bf16 v[84:99], v[116:119], v[104:107], v[84:99]
    s_add_u32 s34, s34, 1
    s_cmp_lt_u32 s34, 32
    s_cbranch_scc1 interleave_layers__grouped_kv_mqa__mixer_channel_mlp__prompt_kernel_fb270
    s_mov_b32 s49, 1
    s_branch interleave_layers__grouped_kv_mqa__mixer_channel_mlp__prompt_kernel_combine60
interleave_layers__grouped_kv_mqa__mixer_channel_mlp__prompt_kernel_after68:
    s_cmp_ge_u32 s3, s41
    s_cbranch_scc1 interleave_layers__grouped_kv_mqa__mixer_channel_mlp__prompt_kernel_le71
    s_mul_i32 s42, s40, 40960
    s_add_u32 s42, s42, 28278784
    buffer_load_dwordx4 v[208:211], v4, s[8:11], s42 offen offset:0 sc1
    buffer_load_dwordx4 v[212:215], v4, s[8:11], s42 offen offset:1024 sc1
    buffer_load_dwordx4 v[216:219], v4, s[8:11], s42 offen offset:2048 sc1
    buffer_load_dwordx4 v[220:223], v4, s[8:11], s42 offen offset:3072 sc1
    s_add_u32 s42, s42, 4096
    buffer_load_dwordx4 v[224:227], v4, s[8:11], s42 offen offset:0 sc1
    buffer_load_dwordx4 v[228:231], v4, s[8:11], s42 offen offset:1024 sc1
    buffer_load_dwordx4 v[232:235], v4, s[8:11], s42 offen offset:2048 sc1
    buffer_load_dwordx4 v[236:239], v4, s[8:11], s42 offen offset:3072 sc1
    s_add_u32 s42, s42, 4096
    buffer_load_dwordx4 v[240:243], v4, s[8:11], s42 offen offset:0 sc1
    buffer_load_dwordx4 v[244:247], v4, s[8:11], s42 offen offset:1024 sc1
    buffer_load_dwordx4 v[248:251], v4, s[8:11], s42 offen offset:2048 sc1
    buffer_load_dwordx4 v[252:255], v4, s[8:11], s42 offen offset:3072 sc1
    s_add_u32 s42, s42, 4096
interleave_layers__grouped_kv_mqa__mixer_channel_mlp__prompt_kernel_le71:
    s_cmp_lg_u32 s3, 7
    s_cbranch_scc1 interleave_layers__grouped_kv_mqa__mixer_channel_mlp__prompt_kernel_w72
    s_add_u32 s28, s13, 2
    v_and_b32 v21, 7, v1
    v_lshlrev_b32 v21, 2, v21
    s_lshl_b32 s29, s6, 8
    v_add_u32 v21, s29, v21
    v_mov_b32 v22, s28
    s_mov_b32 s30, 0
interleave_layers__grouped_kv_mqa__mixer_channel_mlp__prompt_kernel_poll73:
    buffer_load_dword v16, v21, s[8:11], 0 offen offset:0 sc1
    s_waitcnt vmcnt(0)
    v_sub_u32 v16, v16, v22
    v_cmp_le_u32 vcc, 32, v16
    s_cbranch_vccz interleave_layers__grouped_kv_mqa__mixer_channel_mlp__prompt_kernel_pd74
    s_sleep 1
    s_add_u32 s30, s30, 1
    s_cmp_lt_u32 s30, 0x40000
    s_cbranch_scc1 interleave_layers__grouped_kv_mqa__mixer_channel_mlp__prompt_kernel_poll73
interleave_layers__grouped_kv_mqa__mixer_channel_mlp__prompt_kernel_pd74:
interleave_layers__grouped_kv_mqa__mixer_channel_mlp__prompt_kernel_w72:
    s_barrier
    s_lshl_b32 s28, s6, 2
    s_add_u32 s28, s28, s4
    s_mul_i32 s28, s28, 20
    s_mul_i32 s29, s5, 10
    s_add_u32 s28, s28, s29
    s_lshl_b32 s28, s28, 10
    s_mul_i32 s29, s12, 2621440
    s_add_u32 s28, s28, s29
    s_add_u32 s28, s28, 491520
    buffer_load_dwordx4 v[24:27], v4, s[8:11], s28 offen offset:0 sc1
    buffer_load_dwordx4 v[28:31], v4, s[8:11], s28 offen offset:1024 sc1
    buffer_load_dwordx4 v[32:35], v4, s[8:11], s28 offen offset:2048 sc1
    buffer_load_dwordx4 v[36:39], v4, s[8:11], s28 offen offset:3072 sc1
    s_add_u32 s28, s28, 4096
    buffer_load_dwordx4 v[40:43], v4, s[8:11], s28 offen offset:0 sc1
    buffer_load_dwordx4 v[44:47], v4, s[8:11], s28 offen offset:1024 sc1
    buffer_load_dwordx4 v[48:51], v4, s[8:11], s28 offen offset:2048 sc1
    buffer_load_dwordx4 v[52:55], v4, s[8:11], s28 offen offset:3072 sc1
    s_add_u32 s28, s28, 4096
    buffer_load_dwordx4 v[56:59], v4, s[8:11], s28 offen offset:0 sc1
    buffer_load_dwordx4 v[60:63], v4, s[8:11], s28 offen offset:1024 sc1
    s_mul_i32 s28, s5, 10240
    v_add_u32 v144, s28, v4
    v_add_u32 v145, 61440, v144
    ds_read_b128 v[64:67], v144 offset:0
    ds_read_b128 v[68:71], v144 offset:20480
    ds_read_b128 v[72:75], v144 offset:40960
    ds_read_b128 v[76:79], v145 offset:0
    ds_read_b128 v[80:83], v145 offset:20480
    ds_read_b128 v[84:87], v144 offset:1024
    ds_read_b128 v[88:91], v144 offset:21504
    ds_read_b128 v[92:95], v144 offset:41984
    s_waitcnt lgkmcnt(7) vmcnt(9)
    v_mfma_f32_16x16x32_bf16 v[96:99], v[64:67], v[24:27], 0
    ds_read_b128 v[64:67], v145 offset:1024
    s_waitcnt lgkmcnt(7)
    v_mfma_f32_16x16x32_bf16 v[100:103], v[68:71], v[24:27], 0
    ds_read_b128 v[68:71], v145 offset:21504
    s_waitcnt lgkmcnt(7)
    v_mfma_f32_16x16x32_bf16 v[104:107], v[72:75], v[24:27], 0
    ds_read_b128 v[72:75], v144 offset:2048
    s_waitcnt lgkmcnt(7)
    v_mfma_f32_16x16x32_bf16 v[108:111], v[76:79], v[24:27], 0
    ds_read_b128 v[76:79], v144 offset:22528
    s_waitcnt lgkmcnt(7)
    v_mfma_f32_16x16x32_bf16 v[112:115], v[80:83], v[24:27], 0
    ds_read_b128 v[80:83], v144 offset:43008
    s_waitcnt lgkmcnt(7) vmcnt(8)
    v_mfma_f32_16x16x32_bf16 v[96:99], v[84:87], v[28:31], v[96:99]
    ds_read_b128 v[84:87], v145 offset:2048
    s_waitcnt lgkmcnt(7)
    v_mfma_f32_16x16x32_bf16 v[100:103], v[88:91], v[28:31], v[100:103]
    ds_read_b128 v[88:91], v145 offset:22528
    s_waitcnt lgkmcnt(7)
    v_mfma_f32_16x16x32_bf16 v[104:107], v[92:95], v[28:31], v[104:107]
    ds_read_b128 v[92:95], v144 offset:3072
    s_waitcnt lgkmcnt(7)
    v_mfma_f32_16x16x32_bf16 v[108:111], v[64:67], v[28:31], v[108:111]
    ds_read_b128 v[64:67], v144 offset:23552
    s_waitcnt lgkmcnt(7)
    v_mfma_f32_16x16x32_bf16 v[112:115], v[68:71], v[28:31], v[112:115]
    ds_read_b128 v[68:71], v144 offset:44032
    s_waitcnt lgkmcnt(7) vmcnt(7)
    v_mfma_f32_16x16x32_bf16 v[96:99], v[72:75], v[32:35], v[96:99]
    ds_read_b128 v[72:75], v145 offset:3072
    s_waitcnt lgkmcnt(7)
    v_mfma_f32_16x16x32_bf16 v[100:103], v[76:79], v[32:35], v[100:103]
    ds_read_b128 v[76:79], v145 offset:23552
    s_waitcnt lgkmcnt(7)
    v_mfma_f32_16x16x32_bf16 v[104:107], v[80:83], v[32:35], v[104:107]
    ds_read_b128 v[80:83], v144 offset:4096
    s_waitcnt lgkmcnt(7)
    v_mfma_f32_16x16x32_bf16 v[108:111], v[84:87], v[32:35], v[108:111]
    ds_read_b128 v[84:87], v144 offset:24576
    s_waitcnt lgkmcnt(7)
    v_mfma_f32_16x16x32_bf16 v[112:115], v[88:91], v[32:35], v[112:115]
    ds_read_b128 v[88:91], v144 offset:45056
    s_waitcnt lgkmcnt(7) vmcnt(6)
    v_mfma_f32_16x16x32_bf16 v[96:99], v[92:95], v[36:39], v[96:99]
    ds_read_b128 v[92:95], v145 offset:4096
    s_waitcnt lgkmcnt(7)
    v_mfma_f32_16x16x32_bf16 v[100:103], v[64:67], v[36:39], v[100:103]
    ds_read_b128 v[64:67], v145 offset:24576
    s_waitcnt lgkmcnt(7)
    v_mfma_f32_16x16x32_bf16 v[104:107], v[68:71], v[36:39], v[104:107]
    ds_read_b128 v[68:71], v144 offset:5120
    s_waitcnt lgkmcnt(7)
    v_mfma_f32_16x16x32_bf16 v[108:111], v[72:75], v[36:39], v[108:111]
    ds_read_b128 v[72:75], v144 offset:25600
    s_waitcnt lgkmcnt(7)
    v_mfma_f32_16x16x32_bf16 v[112:115], v[76:79], v[36:39], v[112:115]
    ds_read_b128 v[76:79], v144 offset:46080
    s_waitcnt lgkmcnt(7) vmcnt(5)
    v_mfma_f32_16x16x32_bf16 v[96:99], v[80:83], v[40:43], v[96:99]
    ds_read_b128 v[80:83], v145 offset:5120
    s_waitcnt lgkmcnt(7)
    v_mfma_f32_16x16x32_bf16 v[100:103], v[84:87], v[40:43], v[100:103]
    ds_read_b128 v[84:87], v145 offset:25600
    s_waitcnt lgkmcnt(7)
    v_mfma_f32_16x16x32_bf16 v[104:107], v[88:91], v[40:43], v[104:107]
    ds_read_b128 v[88:91], v144 offset:6144
    s_waitcnt lgkmcnt(7)
    v_mfma_f32_16x16x32_bf16 v[108:111], v[92:95], v[40:43], v[108:111]
    ds_read_b128 v[92:95], v144 offset:26624
    s_waitcnt lgkmcnt(7)
    v_mfma_f32_16x16x32_bf16 v[112:115], v[64:67], v[40:43], v[112:115]
    ds_read_b128 v[64:67], v144 offset:47104
    s_waitcnt lgkmcnt(7) vmcnt(4)
    v_mfma_f32_16x16x32_bf16 v[96:99], v[68:71], v[44:47], v[96:99]
    ds_read_b128 v[68:71], v145 offset:6144
    s_waitcnt lgkmcnt(7)
    v_mfma_f32_16x16x32_bf16 v[100:103], v[72:75], v[44:47], v[100:103]
    ds_read_b128 v[72:75], v145 offset:26624
    s_waitcnt lgkmcnt(7)
    v_mfma_f32_16x16x32_bf16 v[104:107], v[76:79], v[44:47], v[104:107]
    ds_read_b128 v[76:79], v144 offset:7168
    s_waitcnt lgkmcnt(7)
    v_mfma_f32_16x16x32_bf16 v[108:111], v[80:83], v[44:47], v[108:111]
    ds_read_b128 v[80:83], v144 offset:27648
    s_waitcnt lgkmcnt(7)
    v_mfma_f32_16x16x32_bf16 v[112:115], v[84:87], v[44:47], v[112:115]
    ds_read_b128 v[84:87], v144 offset:48128
    s_waitcnt lgkmcnt(7) vmcnt(3)
    v_mfma_f32_16x16x32_bf16 v[96:99], v[88:91], v[48:51], v[96:99]
    ds_read_b128 v[88:91], v145 offset:7168
    s_waitcnt lgkmcnt(7)
    v_mfma_f32_16x16x32_bf16 v[100:103], v[92:95], v[48:51], v[100:103]
    ds_read_b128 v[92:95], v145 offset:27648
    s_waitcnt lgkmcnt(7)
    v_mfma_f32_16x16x32_bf16 v[104:107], v[64:67], v[48:51], v[104:107]
    ds_read_b128 v[64:67], v144 offset:8192
    s_waitcnt lgkmcnt(7)
    v_mfma_f32_16x16x32_bf16 v[108:111], v[68:71], v[48:51], v[108:111]
    ds_read_b128 v[68:71], v144 offset:28672
    s_waitcnt lgkmcnt(7)
    v_mfma_f32_16x16x32_bf16 v[112:115], v[72:75], v[48:51], v[112:115]
    ds_read_b128 v[72:75], v144 offset:49152
    s_waitcnt lgkmcnt(7) vmcnt(2)
    v_mfma_f32_16x16x32_bf16 v[96:99], v[76:79], v[52:55], v[96:99]
    ds_read_b128 v[76:79], v145 offset:8192
    s_waitcnt lgkmcnt(7)
    v_mfma_f32_16x16x32_bf16 v[100:103], v[80:83], v[52:55], v[100:103]
    ds_read_b128 v[80:83], v145 offset:28672
    s_waitcnt lgkmcnt(7)
    v_mfma_f32_16x16x32_bf16 v[104:107], v[84:87], v[52:55], v[104:107]
    ds_read_b128 v[84:87], v144 offset:9216
    s_waitcnt lgkmcnt(7)
    v_mfma_f32_16x16x32_bf16 v[108:111], v[88:91], v[52:55], v[108:111]
    ds_read_b128 v[88:91], v144 offset:29696
    s_waitcnt lgkmcnt(7)
    v_mfma_f32_16x16x32_bf16 v[112:115], v[92:95], v[52:55], v[112:115]
    ds_read_b128 v[92:95], v144 offset:50176
    s_waitcnt lgkmcnt(7) vmcnt(1)
    v_mfma_f32_16x16x32_bf16 v[96:99], v[64:67], v[56:59], v[96:99]
    ds_read_b128 v[64:67], v145 offset:9216
    s_waitcnt lgkmcnt(7)
    v_mfma_f32_16x16x32_bf16 v[100:103], v[68:71], v[56:59], v[100:103]
    ds_read_b128 v[68:71], v145 offset:29696
    s_waitcnt lgkmcnt(7)
    v_mfma_f32_16x16x32_bf16 v[104:107], v[72:75], v[56:59], v[104:107]
    s_waitcnt lgkmcnt(6)
    v_mfma_f32_16x16x32_bf16 v[108:111], v[76:79], v[56:59], v[108:111]
    s_waitcnt lgkmcnt(5)
    v_mfma_f32_16x16x32_bf16 v[112:115], v[80:83], v[56:59], v[112:115]
    s_waitcnt lgkmcnt(4) vmcnt(0)
    v_mfma_f32_16x16x32_bf16 v[96:99], v[84:87], v[60:63], v[96:99]
    s_waitcnt lgkmcnt(3)
    v_mfma_f32_16x16x32_bf16 v[100:103], v[88:91], v[60:63], v[100:103]
    s_waitcnt lgkmcnt(2)
    v_mfma_f32_16x16x32_bf16 v[104:107], v[92:95], v[60:63], v[104:107]
    s_waitcnt lgkmcnt(1)
    v_mfma_f32_16x16x32_bf16 v[108:111], v[64:67], v[60:63], v[108:111]
    s_waitcnt lgkmcnt(0)
    v_mfma_f32_16x16x32_bf16 v[112:115], v[68:71], v[60:63], v[112:115]
    s_mul_i32 s28, s4, 5120
    s_add_u32 s28, s28, 102400
    v_add_u32 v153, s28, v4
    s_cmp_eq_u32 s5, 1
    s_cbranch_scc1 interleave_layers__grouped_kv_mqa__mixer_channel_mlp__prompt_kernel_r175
    s_nop 0
    ds_write_b128 v153, v[108:111] offset:3072
    s_nop 0
    ds_write_b128 v153, v[112:115] offset:4096
    s_branch interleave_layers__grouped_kv_mqa__mixer_channel_mlp__prompt_kernel_r276
interleave_layers__grouped_kv_mqa__mixer_channel_mlp__prompt_kernel_r175:
    ds_write_b128 v153, v[96:99] offset:0
    ds_write_b128 v153, v[100:103] offset:1024
    ds_write_b128 v153, v[104:107] offset:2048
    v_mov_b32 v96, v108
    v_mov_b32 v97, v109
    v_mov_b32 v98, v110
    v_mov_b32 v99, v111
    v_mov_b32 v100, v112
    v_mov_b32 v101, v113
    v_mov_b32 v102, v114
    v_mov_b32 v103, v115
interleave_layers__grouped_kv_mqa__mixer_channel_mlp__prompt_kernel_r276:
    s_waitcnt lgkmcnt(0)
    s_barrier
    s_mul_i32 s29, s5, 3072
    v_add_u32 v153, s29, v153
    ds_read_b128 v[24:27], v153 offset:0
    ds_read_b128 v[28:31], v153 offset:1024
    ds_read_b128 v[32:35], v153 offset:2048
    s_waitcnt lgkmcnt(0)
    v_add_f32 v96, v96, v24
    v_add_f32 v97, v97, v25
    v_add_f32 v98, v98, v26
    v_add_f32 v99, v99, v27
    v_add_f32 v100, v100, v28
    v_add_f32 v101, v101, v29
    v_add_f32 v102, v102, v30
    v_add_f32 v103, v103, v31
    v_add_f32 v104, v104, v32
    v_add_f32 v105, v105, v33
    v_add_f32 v106, v106, v34
    v_add_f32 v107, v107, v35
    s_lshl_b32 s28, s6, 2
    s_add_u32 s28, s28, s4
    s_mul_i32 s28, s28, 20480
    s_mul_i32 s29, s7, 5
    s_mul_i32 s30, s5, 3
    s_add_u32 s29, s29, s30
    s_add_u32 s30, s29, 0
    s_lshl_b32 s30, s30, 9
    s_add_u32 s44, s30, s28
    s_add_u32 s30, s29, 1
    s_lshl_b32 s30, s30, 9
    s_add_u32 s45, s30, s28
    s_add_u32 s30, s29, 2
    s_lshl_b32 s30, s30, 9
    s_add_u32 s46, s30, s28
    s_mul_i32 s28, s12, 2621440
    s_add_u32 s28, s28, 5734400
    s_add_u32 s44, s44, s28
    s_add_u32 s45, s45, s28
    s_add_u32 s46, s46, s28
    s_mov_b32 s47, 0xffff0000
    v_lshrrev_b32 v159, 1, v3
    v_lshlrev_b32 v159, 8, v159
    v_lshl_add_u32 v159, v2, 4, v159
    v_and_b32 v158, 1, v3
    v_lshl_add_u32 v159, v158, 3, v159
    v_mov_b32 v154, 0
    v_mov_b32 v155, 0
    v_mov_b32 v156, 0x3f803f80
    v_lshlrev_b32 v144, 16, v8
    v_and_b32 v145, s47, v8
    v_lshlrev_b32 v146, 16, v9
    v_and_b32 v147, s47, v9
    v_add_f32 v96, v96, v144
    v_add_f32 v97, v97, v145
    v_add_f32 v98, v98, v146
    v_add_f32 v99, v99, v147
    v_cvt_pk_bf16_f32 v8, v96, v97
    v_cvt_pk_bf16_f32 v9, v98, v99
    buffer_store_dwordx2 v[8:9], v159, s[8:11], s44 offen sc1
    v_dot2c_f32_bf16 v154, v8, v156
    v_dot2c_f32_bf16 v155, v8, v8
    v_dot2c_f32_bf16 v154, v9, v156
    v_dot2c_f32_bf16 v155, v9, v9
    v_lshlrev_b32 v144, 16, v10
    v_and_b32 v145, s47, v10
    v_lshlrev_b32 v146, 16, v11
    v_and_b32 v147, s47, v11
    v_add_f32 v100, v100, v144
    v_add_f32 v101, v101, v145
    v_add_f32 v102, v102, v146
    v_add_f32 v103, v103, v147
    v_cvt_pk_bf16_f32 v10, v100, v101
    v_cvt_pk_bf16_f32 v11, v102, v103
    buffer_store_dwordx2 v[10:11], v159, s[8:11], s45 offen sc1
    v_dot2c_f32_bf16 v154, v10, v156
    v_dot2c_f32_bf16 v155, v10, v10
    v_dot2c_f32_bf16 v154, v11, v156
    v_dot2c_f32_bf16 v155, v11, v11
    s_cmp_eq_u32 s5, 1
    s_cbranch_scc1 interleave_layers__grouped_kv_mqa__mixer_channel_mlp__prompt_kernel_e377
    v_lshlrev_b32 v144, 16, v12
    v_and_b32 v145, s47, v12
    v_lshlrev_b32 v146, 16, v13
    v_and_b32 v147, s47, v13
    v_add_f32 v104, v104, v144
    v_add_f32 v105, v105, v145
    v_add_f32 v106, v106, v146
    v_add_f32 v107, v107, v147
    v_cvt_pk_bf16_f32 v12, v104, v105
    v_cvt_pk_bf16_f32 v13, v106, v107
    buffer_store_dwordx2 v[12:13], v159, s[8:11], s46 offen sc1
    v_dot2c_f32_bf16 v154, v12, v156
    v_dot2c_f32_bf16 v155, v12, v12
    v_dot2c_f32_bf16 v154, v13, v156
    v_dot2c_f32_bf16 v155, v13, v13
interleave_layers__grouped_kv_mqa__mixer_channel_mlp__prompt_kernel_e377:
    s_nop 1
    v_mov_b32 v157, v154
    s_nop 1
    v_permlane16_swap_b32 v154, v157
    v_add_f32 v154, v154, v157
    v_mov_b32 v157, v154
    s_nop 1
    v_permlane32_swap_b32 v154, v157
    v_add_f32 v154, v154, v157
    v_mov_b32 v157, v155
    s_nop 1
    v_permlane16_swap_b32 v155, v157
    v_add_f32 v155, v155, v157
    v_mov_b32 v157, v155
    s_nop 1
    v_permlane32_swap_b32 v155, v157
    v_add_f32 v155, v155, v157
    v_lshlrev_b32 v157, 3, v2
    s_lshl_b32 s28, s6, 4
    s_lshl_b32 s29, s7, 1
    s_add_u32 s28, s28, s29
    s_add_u32 s28, s28, s5
    s_lshl_b32 s28, s28, 9
    s_lshl_b32 s29, s4, 7
    s_add_u32 s28, s28, s29
    s_mul_i32 s29, s12, 262144
    s_add_u32 s28, s28, s29
    s_add_u32 s28, s28, 10977280
    v_cmp_eq_u32 vcc, 0, v3
    v_mov_b32 v158, 0x40000000
    s_nop 0
    v_cndmask_b32 v157, v158, v157, vcc
    buffer_store_dwordx2 v[154:155], v157, s[8:11], s28 offen sc1
    s_waitcnt vmcnt(0)
    s_barrier
    s_cmp_lg_u32 s3, 0
    s_cbranch_scc1 interleave_layers__grouped_kv_mqa__mixer_channel_mlp__prompt_kernel_pub78
    s_add_u32 s28, s13, 3
    v_mov_b32 v22, s28
    s_lshl_b32 s29, s6, 8
    s_lshl_b32 s30, s7, 2
    s_add_u32 s29, s29, s30
    v_mov_b32 v21, s29
    s_mov_b64 exec, 1
    buffer_store_dword v22, v21, s[8:11], 0 offen offset:0 sc1
    s_mov_b64 exec, -1
interleave_layers__grouped_kv_mqa__mixer_channel_mlp__prompt_kernel_pub78:
    s_cmp_ge_u32 s3, s41
    s_cbranch_scc1 interleave_layers__grouped_kv_mqa__mixer_channel_mlp__prompt_kernel_ew79
    s_mul_i32 s42, s40, 40960
    s_add_u32 s42, s42, 28291072
    buffer_load_dwordx4 v[96:99], v4, s[8:11], s42 offen offset:0 sc1
    buffer_load_dwordx4 v[100:103], v4, s[8:11], s42 offen offset:1024 sc1
    buffer_load_dwordx4 v[104:107], v4, s[8:11], s42 offen offset:2048 sc1
    buffer_load_dwordx4 v[108:111], v4, s[8:11], s42 offen offset:3072 sc1
    s_add_u32 s42, s42, 4096
    buffer_load_dwordx4 v[112:115], v4, s[8:11], s42 offen offset:0 sc1
    buffer_load_dwordx4 v[116:119], v4, s[8:11], s42 offen offset:1024 sc1
    buffer_load_dwordx4 v[120:123], v4, s[8:11], s42 offen offset:2048 sc1
    buffer_load_dwordx4 v[124:127], v4, s[8:11], s42 offen offset:3072 sc1
    s_add_u32 s42, s42, 4096
    buffer_load_dwordx4 v[128:131], v4, s[8:11], s42 offen offset:0 sc1
    buffer_load_dwordx4 v[132:135], v4, s[8:11], s42 offen offset:1024 sc1
    buffer_load_dwordx4 v[136:139], v4, s[8:11], s42 offen offset:2048 sc1
    buffer_load_dwordx4 v[140:143], v4, s[8:11], s42 offen offset:3072 sc1
    s_add_u32 s42, s42, 4096
interleave_layers__grouped_kv_mqa__mixer_channel_mlp__prompt_kernel_ew79:
    s_cmp_lg_u32 s3, 7
    s_cbranch_scc1 interleave_layers__grouped_kv_mqa__mixer_channel_mlp__prompt_kernel_w80
    s_add_u32 s28, s13, 3
    v_and_b32 v21, 7, v1
    v_lshlrev_b32 v21, 2, v21
    s_lshl_b32 s29, s6, 8
    v_add_u32 v21, s29, v21
    v_mov_b32 v22, s28
    s_mov_b32 s30, 0
interleave_layers__grouped_kv_mqa__mixer_channel_mlp__prompt_kernel_poll81:
    buffer_load_dword v16, v21, s[8:11], 0 offen offset:0 sc1
    s_waitcnt vmcnt(0)
    v_sub_u32 v16, v16, v22
    v_cmp_le_u32 vcc, 32, v16
    s_cbranch_vccz interleave_layers__grouped_kv_mqa__mixer_channel_mlp__prompt_kernel_pd82
    s_sleep 1
    s_add_u32 s30, s30, 1
    s_cmp_lt_u32 s30, 0x40000
    s_cbranch_scc1 interleave_layers__grouped_kv_mqa__mixer_channel_mlp__prompt_kernel_poll81
interleave_layers__grouped_kv_mqa__mixer_channel_mlp__prompt_kernel_pd82:
interleave_layers__grouped_kv_mqa__mixer_channel_mlp__prompt_kernel_w80:
    s_barrier
    s_mul_i32 s28, s6, 81920
    s_mul_i32 s29, s12, 2621440
    s_add_u32 s28, s28, s29
    s_add_u32 s28, s28, 5734400
    s_mul_i32 s29, s3, 5120
    s_add_u32 s28, s28, s29
    s_add_u32 m0, s29, 0
    s_nop 0
    buffer_load_dwordx4 v4, s[8:11], s28 offen sc1 lds
    s_add_u32 s28, s28, 1024
    s_add_u32 m0, s29, 1024
    s_nop 0
    buffer_load_dwordx4 v4, s[8:11], s28 offen sc1 lds
    s_add_u32 s28, s28, 1024
    s_add_u32 m0, s29, 2048
    s_nop 0
    buffer_load_dwordx4 v4, s[8:11], s28 offen sc1 lds
    s_add_u32 s28, s28, 1024
    s_add_u32 m0, s29, 3072
    s_nop 0
    buffer_load_dwordx4 v4, s[8:11], s28 offen sc1 lds
    s_add_u32 s28, s28, 1024
    s_add_u32 m0, s29, 4096
    s_nop 0
    buffer_load_dwordx4 v4, s[8:11], s28 offen sc1 lds
    s_add_u32 s28, s28, 36864
    s_add_u32 m0, s29, 40960
    s_nop 0
    buffer_load_dwordx4 v4, s[8:11], s28 offen sc1 lds
    s_add_u32 s28, s28, 1024
    s_add_u32 m0, s29, 41984
    s_nop 0
    buffer_load_dwordx4 v4, s[8:11], s28 offen sc1 lds
    s_add_u32 s28, s28, 1024
    s_add_u32 m0, s29, 43008
    s_nop 0
    buffer_load_dwordx4 v4, s[8:11], s28 offen sc1 lds
    s_add_u32 s28, s28, 1024
    s_add_u32 m0, s29, 44032
    s_nop 0
    buffer_load_dwordx4 v4, s[8:11], s28 offen sc1 lds
    s_add_u32 s28, s28, 1024
    s_add_u32 m0, s29, 45056
    s_nop 0
    buffer_load_dwordx4 v4, s[8:11], s28 offen sc1 lds
    s_add_u32 s28, s28, 36864
    s_cmp_lt_u32 s3, s41
    s_cbranch_scc1 interleave_layers__grouped_kv_mqa__mixer_channel_mlp__prompt_kernel_act83
    s_waitcnt vmcnt(5)
    s_barrier
    s_cmp_lg_u32 s3, 7
    s_cbranch_scc1 interleave_layers__grouped_kv_mqa__mixer_channel_mlp__prompt_kernel_n7w86
    v_lshlrev_b32 v96, 3, v1
    s_lshl_b32 s28, s6, 13
    s_mul_i32 s29, s12, 262144
    s_add_u32 s28, s28, s29
    s_add_u32 s28, s28, 10977280
    buffer_load_dwordx2 v[24:25], v96, s[8:11], s28 offen offset:0 sc1
    buffer_load_dwordx2 v[26:27], v96, s[8:11], s28 offen offset:512 sc1
    buffer_load_dwordx2 v[28:29], v96, s[8:11], s28 offen offset:1024 sc1
    buffer_load_dwordx2 v[30:31], v96, s[8:11], s28 offen offset:1536 sc1
    buffer_load_dwordx2 v[32:33], v96, s[8:11], s28 offen offset:2048 sc1
    buffer_load_dwordx2 v[34:35], v96, s[8:11], s28 offen offset:2560 sc1
    buffer_load_dwordx2 v[36:37], v96, s[8:11], s28 offen offset:3072 sc1
    buffer_load_dwordx2 v[38:39], v96, s[8:11], s28 offen offset:3584 sc1
    s_add_u32 s28, s28, 4096
    buffer_load_dwordx2 v[40:41], v96, s[8:11], s28 offen offset:0 sc1
    buffer_load_dwordx2 v[42:43], v96, s[8:11], s28 offen offset:512 sc1
    buffer_load_dwordx2 v[44:45], v96, s[8:11], s28 offen offset:1024 sc1
    buffer_load_dwordx2 v[46:47], v96, s[8:11], s28 offen offset:1536 sc1
    buffer_load_dwordx2 v[48:49], v96, s[8:11], s28 offen offset:2048 sc1
    buffer_load_dwordx2 v[50:51], v96, s[8:11], s28 offen offset:2560 sc1
    buffer_load_dwordx2 v[52:53], v96, s[8:11], s28 offen offset:3072 sc1
    buffer_load_dwordx2 v[54:55], v96, s[8:11], s28 offen offset:3584 sc1
    s_waitcnt vmcnt(0)
    v_add_f32 v24, v24, v26
    v_add_f32 v25, v25, v27
    v_add_f32 v24, v24, v28
    v_add_f32 v25, v25, v29
    v_add_f32 v24, v24, v30
    v_add_f32 v25, v25, v31
    v_add_f32 v24, v24, v32
    v_add_f32 v25, v25, v33
    v_add_f32 v24, v24, v34
    v_add_f32 v25, v25, v35
    v_add_f32 v24, v24, v36
    v_add_f32 v25, v25, v37
    v_add_f32 v24, v24, v38
    v_add_f32 v25, v25, v39
    v_add_f32 v24, v24, v40
    v_add_f32 v25, v25, v41
    v_add_f32 v24, v24, v42
    v_add_f32 v25, v25, v43
    v_add_f32 v24, v24, v44
    v_add_f32 v25, v25, v45
    v_add_f32 v24, v24, v46
    v_add_f32 v25, v25, v47
    v_add_f32 v24, v24, v48
    v_add_f32 v25, v25, v49
    v_add_f32 v24, v24, v50
    v_add_f32 v25, v25, v51
    v_add_f32 v24, v24, v52
    v_add_f32 v25, v25, v53
    v_add_f32 v24, v24, v54
    v_add_f32 v25, v25, v55
    v_mul_f32 v98, 0x3acccccd, v24
    v_mul_f32 v25, 0x3acccccd, v25
    v_fma_f32 v25, -v98, v98, v25
    v_max_f32 v25, 0, v25
    v_add_f32 v26, 0x3727c5ac, v25
    v_rsq_f32 v99, v26
    s_nop 0
    v_mul_f32 v27, v99, v99
    v_mul_f32 v27, v27, v25
    v_add_f32 v27, 0x3727c5ac, v27
    v_rsq_f32 v27, v27
    s_nop 0
    v_mul_f32 v99, v99, v27
    v_mul_f32 v98, v98, v99
    v_add_u32 v96, 153600, v96
    ds_write_b64 v96, v[98:99]
    s_waitcnt lgkmcnt(0)
    s_mov_b32 s52, 16
    s_lshr_b32 s53, s52, 1
    s_and_b32 s54, s52, 1
    s_mul_i32 s54, s54, 27
    s_add_u32 s54, s54, s53
    s_mul_i32 s55, s7, 270
    s_add_u32 s54, s54, s55
    s_lshl_b32 s54, s54, 10
    s_add_u32 s54, s54, 30490624
    s_mul_i32 s55, s52, 5120
    s_mov_b32 m0, s55
    s_nop 0
    buffer_load_dwordx4 v4, s[8:11], s54 offen sc1 lds
    s_add_u32 s54, s54, 55296
    s_add_u32 s55, s55, 1024
    s_mov_b32 m0, s55
    s_nop 0
    buffer_load_dwordx4 v4, s[8:11], s54 offen sc1 lds
    s_add_u32 s54, s54, 55296
    s_add_u32 s55, s55, 1024
    s_mov_b32 m0, s55
    s_nop 0
    buffer_load_dwordx4 v4, s[8:11], s54 offen sc1 lds
    s_add_u32 s54, s54, 55296
    s_add_u32 s55, s55, 1024
    s_mov_b32 m0, s55
    s_nop 0
    buffer_load_dwordx4 v4, s[8:11], s54 offen sc1 lds
    s_add_u32 s54, s54, 55296
    s_add_u32 s55, s55, 1024
    s_mov_b32 m0, s55
    s_nop 0
    buffer_load_dwordx4 v4, s[8:11], s54 offen sc1 lds
    s_add_u32 s54, s54, 55296
    s_add_u32 s55, s55, 1024
    s_mov_b32 s52, 17
    s_lshr_b32 s53, s52, 1
    s_and_b32 s54, s52, 1
    s_mul_i32 s54, s54, 27
    s_add_u32 s54, s54, s53
    s_mul_i32 s55, s7, 270
    s_add_u32 s54, s54, s55
    s_lshl_b32 s54, s54, 10
    s_add_u32 s54, s54, 30490624
    s_mul_i32 s55, s52, 5120
    s_mov_b32 m0, s55
    s_nop 0
    buffer_load_dwordx4 v4, s[8:11], s54 offen sc1 lds
    s_add_u32 s54, s54, 55296
    s_add_u32 s55, s55, 1024
    s_mov_b32 m0, s55
    s_nop 0
    buffer_load_dwordx4 v4, s[8:11], s54 offen sc1 lds
    s_add_u32 s54, s54, 55296
    s_add_u32 s55, s55, 1024
    s_mov_b32 m0, s55
    s_nop 0
    buffer_load_dwordx4 v4, s[8:11], s54 offen sc1 lds
    s_add_u32 s54, s54, 55296
    s_add_u32 s55, s55, 1024
    s_mov_b32 m0, s55
    s_nop 0
    buffer_load_dwordx4 v4, s[8:11], s54 offen sc1 lds
    s_add_u32 s54, s54, 55296
    s_add_u32 s55, s55, 1024
    s_mov_b32 m0, s55
    s_nop 0
    buffer_load_dwordx4 v4, s[8:11], s54 offen sc1 lds
    s_add_u32 s54, s54, 55296
    s_add_u32 s55, s55, 1024
    s_mov_b32 s52, 18
    s_lshr_b32 s53, s52, 1
    s_and_b32 s54, s52, 1
    s_mul_i32 s54, s54, 27
    s_add_u32 s54, s54, s53
    s_mul_i32 s55, s7, 270
    s_add_u32 s54, s54, s55
    s_lshl_b32 s54, s54, 10
    s_add_u32 s54, s54, 30490624
    s_mul_i32 s55, s52, 5120
    s_mov_b32 m0, s55
    s_nop 0
    buffer_load_dwordx4 v4, s[8:11], s54 offen sc1 lds
    s_add_u32 s54, s54, 55296
    s_add_u32 s55, s55, 1024
    s_mov_b32 m0, s55
    s_nop 0
    buffer_load_dwordx4 v4, s[8:11], s54 offen sc1 lds
    s_add_u32 s54, s54, 55296
    s_add_u32 s55, s55, 1024
    s_mov_b32 m0, s55
    s_nop 0
    buffer_load_dwordx4 v4, s[8:11], s54 offen sc1 lds
    s_add_u32 s54, s54, 55296
    s_add_u32 s55, s55, 1024
    s_mov_b32 m0, s55
    s_nop 0
    buffer_load_dwordx4 v4, s[8:11], s54 offen sc1 lds
    s_add_u32 s54, s54, 55296
    s_add_u32 s55, s55, 1024
    s_mov_b32 m0, s55
    s_nop 0
    buffer_load_dwordx4 v4, s[8:11], s54 offen sc1 lds
    s_add_u32 s54, s54, 55296
    s_add_u32 s55, s55, 1024
    s_mov_b32 s52, 19
    s_lshr_b32 s53, s52, 1
    s_and_b32 s54, s52, 1
    s_mul_i32 s54, s54, 27
    s_add_u32 s54, s54, s53
    s_mul_i32 s55, s7, 270
    s_add_u32 s54, s54, s55
    s_lshl_b32 s54, s54, 10
    s_add_u32 s54, s54, 30490624
    s_mul_i32 s55, s52, 5120
    s_mov_b32 m0, s55
    s_nop 0
    buffer_load_dwordx4 v4, s[8:11], s54 offen sc1 lds
    s_add_u32 s54, s54, 55296
    s_add_u32 s55, s55, 1024
    s_mov_b32 m0, s55
    s_nop 0
    buffer_load_dwordx4 v4, s[8:11], s54 offen sc1 lds
    s_add_u32 s54, s54, 55296
    s_add_u32 s55, s55, 1024
    s_mov_b32 m0, s55
    s_nop 0
    buffer_load_dwordx4 v4, s[8:11], s54 offen sc1 lds
    s_add_u32 s54, s54, 55296
    s_add_u32 s55, s55, 1024
    s_mov_b32 m0, s55
    s_nop 0
    buffer_load_dwordx4 v4, s[8:11], s54 offen sc1 lds
    s_add_u32 s54, s54, 55296
    s_add_u32 s55, s55, 1024
    s_mov_b32 m0, s55
    s_nop 0
    buffer_load_dwordx4 v4, s[8:11], s54 offen sc1 lds
    s_add_u32 s54, s54, 55296
    s_add_u32 s55, s55, 1024
    s_mov_b32 s52, 20
    s_lshr_b32 s53, s52, 1
    s_and_b32 s54, s52, 1
    s_mul_i32 s54, s54, 27
    s_add_u32 s54, s54, s53
    s_mul_i32 s55, s7, 270
    s_add_u32 s54, s54, s55
    s_lshl_b32 s54, s54, 10
    s_add_u32 s54, s54, 30490624
    s_mul_i32 s55, s52, 5120
    s_mov_b32 m0, s55
    s_nop 0
    buffer_load_dwordx4 v4, s[8:11], s54 offen sc1 lds
    s_add_u32 s54, s54, 55296
    s_add_u32 s55, s55, 1024
    s_mov_b32 m0, s55
    s_nop 0
    buffer_load_dwordx4 v4, s[8:11], s54 offen sc1 lds
    s_add_u32 s54, s54, 55296
    s_add_u32 s55, s55, 1024
    s_mov_b32 m0, s55
    s_nop 0
    buffer_load_dwordx4 v4, s[8:11], s54 offen sc1 lds
    s_add_u32 s54, s54, 55296
    s_add_u32 s55, s55, 1024
    s_mov_b32 m0, s55
    s_nop 0
    buffer_load_dwordx4 v4, s[8:11], s54 offen sc1 lds
    s_add_u32 s54, s54, 55296
    s_add_u32 s55, s55, 1024
    s_mov_b32 m0, s55
    s_nop 0
    buffer_load_dwordx4 v4, s[8:11], s54 offen sc1 lds
    s_add_u32 s54, s54, 55296
    s_add_u32 s55, s55, 1024
    s_mov_b32 s52, 21
    s_lshr_b32 s53, s52, 1
    s_and_b32 s54, s52, 1
    s_mul_i32 s54, s54, 27
    s_add_u32 s54, s54, s53
    s_mul_i32 s55, s7, 270
    s_add_u32 s54, s54, s55
    s_lshl_b32 s54, s54, 10
    s_add_u32 s54, s54, 30490624
    s_mul_i32 s55, s52, 5120
    s_mov_b32 m0, s55
    s_nop 0
    buffer_load_dwordx4 v4, s[8:11], s54 offen sc1 lds
    s_add_u32 s54, s54, 55296
    s_add_u32 s55, s55, 1024
    s_mov_b32 m0, s55
    s_nop 0
    buffer_load_dwordx4 v4, s[8:11], s54 offen sc1 lds
    s_add_u32 s54, s54, 55296
    s_add_u32 s55, s55, 1024
    s_mov_b32 m0, s55
    s_nop 0
    buffer_load_dwordx4 v4, s[8:11], s54 offen sc1 lds
    s_add_u32 s54, s54, 55296
    s_add_u32 s55, s55, 1024
    s_mov_b32 m0, s55
    s_nop 0
    buffer_load_dwordx4 v4, s[8:11], s54 offen sc1 lds
    s_add_u32 s54, s54, 55296
    s_add_u32 s55, s55, 1024
    s_mov_b32 m0, s55
    s_nop 0
    buffer_load_dwordx4 v4, s[8:11], s54 offen sc1 lds
    s_add_u32 s54, s54, 55296
    s_add_u32 s55, s55, 1024
    s_mov_b32 s52, 22
    s_lshr_b32 s53, s52, 1
    s_and_b32 s54, s52, 1
    s_mul_i32 s54, s54, 27
    s_add_u32 s54, s54, s53
    s_mul_i32 s55, s7, 270
    s_add_u32 s54, s54, s55
    s_lshl_b32 s54, s54, 10
    s_add_u32 s54, s54, 30490624
    s_mul_i32 s55, s52, 5120
    s_mov_b32 m0, s55
    s_nop 0
    buffer_load_dwordx4 v4, s[8:11], s54 offen sc1 lds
    s_add_u32 s54, s54, 55296
    s_add_u32 s55, s55, 1024
    s_mov_b32 m0, s55
    s_nop 0
    buffer_load_dwordx4 v4, s[8:11], s54 offen sc1 lds
    s_add_u32 s54, s54, 55296
    s_add_u32 s55, s55, 1024
    s_mov_b32 m0, s55
    s_nop 0
    buffer_load_dwordx4 v4, s[8:11], s54 offen sc1 lds
    s_add_u32 s54, s54, 55296
    s_add_u32 s55, s55, 1024
    s_mov_b32 m0, s55
    s_nop 0
    buffer_load_dwordx4 v4, s[8:11], s54 offen sc1 lds
    s_add_u32 s54, s54, 55296
    s_add_u32 s55, s55, 1024
    s_mov_b32 m0, s55
    s_nop 0
    buffer_load_dwordx4 v4, s[8:11], s54 offen sc1 lds
    s_add_u32 s54, s54, 55296
    s_add_u32 s55, s55, 1024
    s_mov_b32 s52, 23
    s_lshr_b32 s53, s52, 1
    s_and_b32 s54, s52, 1
    s_mul_i32 s54, s54, 27
    s_add_u32 s54, s54, s53
    s_mul_i32 s55, s7, 270
    s_add_u32 s54, s54, s55
    s_lshl_b32 s54, s54, 10
    s_add_u32 s54, s54, 30490624
    s_mul_i32 s55, s52, 5120
    s_mov_b32 m0, s55
    s_nop 0
    buffer_load_dwordx4 v4, s[8:11], s54 offen sc1 lds
    s_add_u32 s54, s54, 55296
    s_add_u32 s55, s55, 1024
    s_mov_b32 m0, s55
    s_nop 0
    buffer_load_dwordx4 v4, s[8:11], s54 offen sc1 lds
    s_add_u32 s54, s54, 55296
    s_add_u32 s55, s55, 1024
    s_mov_b32 m0, s55
    s_nop 0
    buffer_load_dwordx4 v4, s[8:11], s54 offen sc1 lds
    s_add_u32 s54, s54, 55296
    s_add_u32 s55, s55, 1024
    s_mov_b32 m0, s55
    s_nop 0
    buffer_load_dwordx4 v4, s[8:11], s54 offen sc1 lds
    s_add_u32 s54, s54, 55296
    s_add_u32 s55, s55, 1024
    s_mov_b32 m0, s55
    s_nop 0
    buffer_load_dwordx4 v4, s[8:11], s54 offen sc1 lds
    s_add_u32 s54, s54, 55296
    s_add_u32 s55, s55, 1024
    s_mov_b32 s52, 24
    s_lshr_b32 s53, s52, 1
    s_and_b32 s54, s52, 1
    s_mul_i32 s54, s54, 27
    s_add_u32 s54, s54, s53
    s_mul_i32 s55, s7, 270
    s_add_u32 s54, s54, s55
    s_lshl_b32 s54, s54, 10
    s_add_u32 s54, s54, 30490624
    s_mul_i32 s55, s52, 5120
    s_mov_b32 m0, s55
    s_nop 0
    buffer_load_dwordx4 v4, s[8:11], s54 offen sc1 lds
    s_add_u32 s54, s54, 55296
    s_add_u32 s55, s55, 1024
    s_mov_b32 m0, s55
    s_nop 0
    buffer_load_dwordx4 v4, s[8:11], s54 offen sc1 lds
    s_add_u32 s54, s54, 55296
    s_add_u32 s55, s55, 1024
    s_mov_b32 m0, s55
    s_nop 0
    buffer_load_dwordx4 v4, s[8:11], s54 offen sc1 lds
    s_add_u32 s54, s54, 55296
    s_add_u32 s55, s55, 1024
    s_mov_b32 m0, s55
    s_nop 0
    buffer_load_dwordx4 v4, s[8:11], s54 offen sc1 lds
    s_add_u32 s54, s54, 55296
    s_add_u32 s55, s55, 1024
    s_mov_b32 m0, s55
    s_nop 0
    buffer_load_dwordx4 v4, s[8:11], s54 offen sc1 lds
    s_add_u32 s54, s54, 55296
    s_add_u32 s55, s55, 1024
    s_mov_b32 s52, 25
    s_lshr_b32 s53, s52, 1
    s_and_b32 s54, s52, 1
    s_mul_i32 s54, s54, 27
    s_add_u32 s54, s54, s53
    s_mul_i32 s55, s7, 270
    s_add_u32 s54, s54, s55
    s_lshl_b32 s54, s54, 10
    s_add_u32 s54, s54, 30490624
    s_mul_i32 s55, s52, 5120
    s_mov_b32 m0, s55
    s_nop 0
    buffer_load_dwordx4 v4, s[8:11], s54 offen sc1 lds
    s_add_u32 s54, s54, 55296
    s_add_u32 s55, s55, 1024
    s_mov_b32 m0, s55
    s_nop 0
    buffer_load_dwordx4 v4, s[8:11], s54 offen sc1 lds
    s_add_u32 s54, s54, 55296
    s_add_u32 s55, s55, 1024
    s_mov_b32 m0, s55
    s_nop 0
    buffer_load_dwordx4 v4, s[8:11], s54 offen sc1 lds
    s_add_u32 s54, s54, 55296
    s_add_u32 s55, s55, 1024
    s_mov_b32 m0, s55
    s_nop 0
    buffer_load_dwordx4 v4, s[8:11], s54 offen sc1 lds
    s_add_u32 s54, s54, 55296
    s_add_u32 s55, s55, 1024
    s_mov_b32 m0, s55
    s_nop 0
    buffer_load_dwordx4 v4, s[8:11], s54 offen sc1 lds
    s_add_u32 s54, s54, 55296
    s_add_u32 s55, s55, 1024
    s_mov_b32 s52, 26
    s_lshr_b32 s53, s52, 1
    s_and_b32 s54, s52, 1
    s_mul_i32 s54, s54, 27
    s_add_u32 s54, s54, s53
    s_mul_i32 s55, s7, 270
    s_add_u32 s54, s54, s55
    s_lshl_b32 s54, s54, 10
    s_add_u32 s54, s54, 30490624
    s_mul_i32 s55, s52, 5120
    s_mov_b32 m0, s55
    s_nop 0
    buffer_load_dwordx4 v4, s[8:11], s54 offen sc1 lds
    s_add_u32 s54, s54, 55296
    s_add_u32 s55, s55, 1024
    s_mov_b32 m0, s55
    s_nop 0
    buffer_load_dwordx4 v4, s[8:11], s54 offen sc1 lds
    s_add_u32 s54, s54, 55296
    s_add_u32 s55, s55, 1024
    s_mov_b32 m0, s55
    s_nop 0
    buffer_load_dwordx4 v4, s[8:11], s54 offen sc1 lds
    s_add_u32 s54, s54, 55296
    s_add_u32 s55, s55, 1024
    s_mov_b32 m0, s55
    s_nop 0
    buffer_load_dwordx4 v4, s[8:11], s54 offen sc1 lds
    s_add_u32 s54, s54, 55296
    s_add_u32 s55, s55, 1024
    s_mov_b32 m0, s55
    s_nop 0
    buffer_load_dwordx4 v4, s[8:11], s54 offen sc1 lds
    s_add_u32 s54, s54, 55296
    s_add_u32 s55, s55, 1024
    s_mov_b32 s52, 27
    s_lshr_b32 s53, s52, 1
    s_and_b32 s54, s52, 1
    s_mul_i32 s54, s54, 27
    s_add_u32 s54, s54, s53
    s_mul_i32 s55, s7, 270
    s_add_u32 s54, s54, s55
    s_lshl_b32 s54, s54, 10
    s_add_u32 s54, s54, 30490624
    s_mul_i32 s55, s52, 5120
    s_mov_b32 m0, s55
    s_nop 0
    buffer_load_dwordx4 v4, s[8:11], s54 offen sc1 lds
    s_add_u32 s54, s54, 55296
    s_add_u32 s55, s55, 1024
    s_mov_b32 m0, s55
    s_nop 0
    buffer_load_dwordx4 v4, s[8:11], s54 offen sc1 lds
    s_add_u32 s54, s54, 55296
    s_add_u32 s55, s55, 1024
    s_mov_b32 m0, s55
    s_nop 0
    buffer_load_dwordx4 v4, s[8:11], s54 offen sc1 lds
    s_add_u32 s54, s54, 55296
    s_add_u32 s55, s55, 1024
    s_mov_b32 m0, s55
    s_nop 0
    buffer_load_dwordx4 v4, s[8:11], s54 offen sc1 lds
    s_add_u32 s54, s54, 55296
    s_add_u32 s55, s55, 1024
    s_mov_b32 m0, s55
    s_nop 0
    buffer_load_dwordx4 v4, s[8:11], s54 offen sc1 lds
    s_add_u32 s54, s54, 55296
    s_add_u32 s55, s55, 1024
    s_mov_b32 s52, 28
    s_lshr_b32 s53, s52, 1
    s_and_b32 s54, s52, 1
    s_mul_i32 s54, s54, 27
    s_add_u32 s54, s54, s53
    s_mul_i32 s55, s7, 270
    s_add_u32 s54, s54, s55
    s_lshl_b32 s54, s54, 10
    s_add_u32 s54, s54, 30490624
    s_mul_i32 s55, s52, 5120
    s_mov_b32 m0, s55
    s_nop 0
    buffer_load_dwordx4 v4, s[8:11], s54 offen sc1 lds
    s_add_u32 s54, s54, 55296
    s_add_u32 s55, s55, 1024
    s_mov_b32 m0, s55
    s_nop 0
    buffer_load_dwordx4 v4, s[8:11], s54 offen sc1 lds
    s_add_u32 s54, s54, 55296
    s_add_u32 s55, s55, 1024
    s_mov_b32 m0, s55
    s_nop 0
    buffer_load_dwordx4 v4, s[8:11], s54 offen sc1 lds
    s_add_u32 s54, s54, 55296
    s_add_u32 s55, s55, 1024
    s_mov_b32 m0, s55
    s_nop 0
    buffer_load_dwordx4 v4, s[8:11], s54 offen sc1 lds
    s_add_u32 s54, s54, 55296
    s_add_u32 s55, s55, 1024
    s_mov_b32 m0, s55
    s_nop 0
    buffer_load_dwordx4 v4, s[8:11], s54 offen sc1 lds
    s_add_u32 s54, s54, 55296
    s_add_u32 s55, s55, 1024
    s_mov_b32 s52, 29
    s_lshr_b32 s53, s52, 1
    s_and_b32 s54, s52, 1
    s_mul_i32 s54, s54, 27
    s_add_u32 s54, s54, s53
    s_mul_i32 s55, s7, 270
    s_add_u32 s54, s54, s55
    s_lshl_b32 s54, s54, 10
    s_add_u32 s54, s54, 30490624
    s_mul_i32 s55, s52, 5120
    s_mov_b32 m0, s55
    s_nop 0
    buffer_load_dwordx4 v4, s[8:11], s54 offen sc1 lds
    s_add_u32 s54, s54, 55296
    s_add_u32 s55, s55, 1024
    s_mov_b32 m0, s55
    s_nop 0
    buffer_load_dwordx4 v4, s[8:11], s54 offen sc1 lds
    s_add_u32 s54, s54, 55296
    s_add_u32 s55, s55, 1024
    s_mov_b32 m0, s55
    s_nop 0
    buffer_load_dwordx4 v4, s[8:11], s54 offen sc1 lds
    s_add_u32 s54, s54, 55296
    s_add_u32 s55, s55, 1024
    s_mov_b32 m0, s55
    s_nop 0
    buffer_load_dwordx4 v4, s[8:11], s54 offen sc1 lds
    s_add_u32 s54, s54, 55296
    s_add_u32 s55, s55, 1024
    s_mov_b32 m0, s55
    s_nop 0
    buffer_load_dwordx4 v4, s[8:11], s54 offen sc1 lds
    s_add_u32 s54, s54, 55296
    s_add_u32 s55, s55, 1024
    s_branch interleave_layers__grouped_kv_mqa__mixer_channel_mlp__prompt_kernel_n785
interleave_layers__grouped_kv_mqa__mixer_channel_mlp__prompt_kernel_n7w86:
    s_waitcnt vmcnt(0)
interleave_layers__grouped_kv_mqa__mixer_channel_mlp__prompt_kernel_n785:
    s_barrier
    s_barrier
    s_cmp_lg_u32 s3, 7
    s_cbranch_scc1 interleave_layers__grouped_kv_mqa__mixer_channel_mlp__prompt_kernel_fin84
    s_mov_b32 s52, 0
    s_lshr_b32 s53, s52, 1
    s_and_b32 s54, s52, 1
    s_mul_i32 s54, s54, 27
    s_add_u32 s54, s54, s53
    s_mul_i32 s55, s7, 270
    s_add_u32 s54, s54, s55
    s_lshl_b32 s54, s54, 10
    s_add_u32 s54, s54, 30490624
    s_mul_i32 s55, s52, 5120
    s_mov_b32 m0, s55
    s_nop 0
    buffer_load_dwordx4 v4, s[8:11], s54 offen sc1 lds
    s_add_u32 s54, s54, 55296
    s_add_u32 s55, s55, 1024
    s_mov_b32 m0, s55
    s_nop 0
    buffer_load_dwordx4 v4, s[8:11], s54 offen sc1 lds
    s_add_u32 s54, s54, 55296
    s_add_u32 s55, s55, 1024
    s_mov_b32 m0, s55
    s_nop 0
    buffer_load_dwordx4 v4, s[8:11], s54 offen sc1 lds
    s_add_u32 s54, s54, 55296
    s_add_u32 s55, s55, 1024
    s_mov_b32 m0, s55
    s_nop 0
    buffer_load_dwordx4 v4, s[8:11], s54 offen sc1 lds
    s_add_u32 s54, s54, 55296
    s_add_u32 s55, s55, 1024
    s_mov_b32 m0, s55
    s_nop 0
    buffer_load_dwordx4 v4, s[8:11], s54 offen sc1 lds
    s_add_u32 s54, s54, 55296
    s_add_u32 s55, s55, 1024
    s_mov_b32 s52, 1
    s_lshr_b32 s53, s52, 1
    s_and_b32 s54, s52, 1
    s_mul_i32 s54, s54, 27
    s_add_u32 s54, s54, s53
    s_mul_i32 s55, s7, 270
    s_add_u32 s54, s54, s55
    s_lshl_b32 s54, s54, 10
    s_add_u32 s54, s54, 30490624
    s_mul_i32 s55, s52, 5120
    s_mov_b32 m0, s55
    s_nop 0
    buffer_load_dwordx4 v4, s[8:11], s54 offen sc1 lds
    s_add_u32 s54, s54, 55296
    s_add_u32 s55, s55, 1024
    s_mov_b32 m0, s55
    s_nop 0
    buffer_load_dwordx4 v4, s[8:11], s54 offen sc1 lds
    s_add_u32 s54, s54, 55296
    s_add_u32 s55, s55, 1024
    s_mov_b32 m0, s55
    s_nop 0
    buffer_load_dwordx4 v4, s[8:11], s54 offen sc1 lds
    s_add_u32 s54, s54, 55296
    s_add_u32 s55, s55, 1024
    s_mov_b32 m0, s55
    s_nop 0
    buffer_load_dwordx4 v4, s[8:11], s54 offen sc1 lds
    s_add_u32 s54, s54, 55296
    s_add_u32 s55, s55, 1024
    s_mov_b32 m0, s55
    s_nop 0
    buffer_load_dwordx4 v4, s[8:11], s54 offen sc1 lds
    s_add_u32 s54, s54, 55296
    s_add_u32 s55, s55, 1024
    s_mov_b32 s52, 2
    s_lshr_b32 s53, s52, 1
    s_and_b32 s54, s52, 1
    s_mul_i32 s54, s54, 27
    s_add_u32 s54, s54, s53
    s_mul_i32 s55, s7, 270
    s_add_u32 s54, s54, s55
    s_lshl_b32 s54, s54, 10
    s_add_u32 s54, s54, 30490624
    s_mul_i32 s55, s52, 5120
    s_mov_b32 m0, s55
    s_nop 0
    buffer_load_dwordx4 v4, s[8:11], s54 offen sc1 lds
    s_add_u32 s54, s54, 55296
    s_add_u32 s55, s55, 1024
    s_mov_b32 m0, s55
    s_nop 0
    buffer_load_dwordx4 v4, s[8:11], s54 offen sc1 lds
    s_add_u32 s54, s54, 55296
    s_add_u32 s55, s55, 1024
    s_mov_b32 m0, s55
    s_nop 0
    buffer_load_dwordx4 v4, s[8:11], s54 offen sc1 lds
    s_add_u32 s54, s54, 55296
    s_add_u32 s55, s55, 1024
    s_mov_b32 m0, s55
    s_nop 0
    buffer_load_dwordx4 v4, s[8:11], s54 offen sc1 lds
    s_add_u32 s54, s54, 55296
    s_add_u32 s55, s55, 1024
    s_mov_b32 m0, s55
    s_nop 0
    buffer_load_dwordx4 v4, s[8:11], s54 offen sc1 lds
    s_add_u32 s54, s54, 55296
    s_add_u32 s55, s55, 1024
    s_mov_b32 s52, 3
    s_lshr_b32 s53, s52, 1
    s_and_b32 s54, s52, 1
    s_mul_i32 s54, s54, 27
    s_add_u32 s54, s54, s53
    s_mul_i32 s55, s7, 270
    s_add_u32 s54, s54, s55
    s_lshl_b32 s54, s54, 10
    s_add_u32 s54, s54, 30490624
    s_mul_i32 s55, s52, 5120
    s_mov_b32 m0, s55
    s_nop 0
    buffer_load_dwordx4 v4, s[8:11], s54 offen sc1 lds
    s_add_u32 s54, s54, 55296
    s_add_u32 s55, s55, 1024
    s_mov_b32 m0, s55
    s_nop 0
    buffer_load_dwordx4 v4, s[8:11], s54 offen sc1 lds
    s_add_u32 s54, s54, 55296
    s_add_u32 s55, s55, 1024
    s_mov_b32 m0, s55
    s_nop 0
    buffer_load_dwordx4 v4, s[8:11], s54 offen sc1 lds
    s_add_u32 s54, s54, 55296
    s_add_u32 s55, s55, 1024
    s_mov_b32 m0, s55
    s_nop 0
    buffer_load_dwordx4 v4, s[8:11], s54 offen sc1 lds
    s_add_u32 s54, s54, 55296
    s_add_u32 s55, s55, 1024
    s_mov_b32 m0, s55
    s_nop 0
    buffer_load_dwordx4 v4, s[8:11], s54 offen sc1 lds
    s_add_u32 s54, s54, 55296
    s_add_u32 s55, s55, 1024
    s_mov_b32 s52, 4
    s_lshr_b32 s53, s52, 1
    s_and_b32 s54, s52, 1
    s_mul_i32 s54, s54, 27
    s_add_u32 s54, s54, s53
    s_mul_i32 s55, s7, 270
    s_add_u32 s54, s54, s55
    s_lshl_b32 s54, s54, 10
    s_add_u32 s54, s54, 30490624
    s_mul_i32 s55, s52, 5120
    s_mov_b32 m0, s55
    s_nop 0
    buffer_load_dwordx4 v4, s[8:11], s54 offen sc1 lds
    s_add_u32 s54, s54, 55296
    s_add_u32 s55, s55, 1024
    s_mov_b32 m0, s55
    s_nop 0
    buffer_load_dwordx4 v4, s[8:11], s54 offen sc1 lds
    s_add_u32 s54, s54, 55296
    s_add_u32 s55, s55, 1024
    s_mov_b32 m0, s55
    s_nop 0
    buffer_load_dwordx4 v4, s[8:11], s54 offen sc1 lds
    s_add_u32 s54, s54, 55296
    s_add_u32 s55, s55, 1024
    s_mov_b32 m0, s55
    s_nop 0
    buffer_load_dwordx4 v4, s[8:11], s54 offen sc1 lds
    s_add_u32 s54, s54, 55296
    s_add_u32 s55, s55, 1024
    s_mov_b32 m0, s55
    s_nop 0
    buffer_load_dwordx4 v4, s[8:11], s54 offen sc1 lds
    s_add_u32 s54, s54, 55296
    s_add_u32 s55, s55, 1024
    s_mov_b32 s52, 5
    s_lshr_b32 s53, s52, 1
    s_and_b32 s54, s52, 1
    s_mul_i32 s54, s54, 27
    s_add_u32 s54, s54, s53
    s_mul_i32 s55, s7, 270
    s_add_u32 s54, s54, s55
    s_lshl_b32 s54, s54, 10
    s_add_u32 s54, s54, 30490624
    s_mul_i32 s55, s52, 5120
    s_mov_b32 m0, s55
    s_nop 0
    buffer_load_dwordx4 v4, s[8:11], s54 offen sc1 lds
    s_add_u32 s54, s54, 55296
    s_add_u32 s55, s55, 1024
    s_mov_b32 m0, s55
    s_nop 0
    buffer_load_dwordx4 v4, s[8:11], s54 offen sc1 lds
    s_add_u32 s54, s54, 55296
    s_add_u32 s55, s55, 1024
    s_mov_b32 m0, s55
    s_nop 0
    buffer_load_dwordx4 v4, s[8:11], s54 offen sc1 lds
    s_add_u32 s54, s54, 55296
    s_add_u32 s55, s55, 1024
    s_mov_b32 m0, s55
    s_nop 0
    buffer_load_dwordx4 v4, s[8:11], s54 offen sc1 lds
    s_add_u32 s54, s54, 55296
    s_add_u32 s55, s55, 1024
    s_mov_b32 m0, s55
    s_nop 0
    buffer_load_dwordx4 v4, s[8:11], s54 offen sc1 lds
    s_add_u32 s54, s54, 55296
    s_add_u32 s55, s55, 1024
    s_mov_b32 s52, 6
    s_lshr_b32 s53, s52, 1
    s_and_b32 s54, s52, 1
    s_mul_i32 s54, s54, 27
    s_add_u32 s54, s54, s53
    s_mul_i32 s55, s7, 270
    s_add_u32 s54, s54, s55
    s_lshl_b32 s54, s54, 10
    s_add_u32 s54, s54, 30490624
    s_mul_i32 s55, s52, 5120
    s_mov_b32 m0, s55
    s_nop 0
    buffer_load_dwordx4 v4, s[8:11], s54 offen sc1 lds
    s_add_u32 s54, s54, 55296
    s_add_u32 s55, s55, 1024
    s_mov_b32 m0, s55
    s_nop 0
    buffer_load_dwordx4 v4, s[8:11], s54 offen sc1 lds
    s_add_u32 s54, s54, 55296
    s_add_u32 s55, s55, 1024
    s_mov_b32 m0, s55
    s_nop 0
    buffer_load_dwordx4 v4, s[8:11], s54 offen sc1 lds
    s_add_u32 s54, s54, 55296
    s_add_u32 s55, s55, 1024
    s_mov_b32 m0, s55
    s_nop 0
    buffer_load_dwordx4 v4, s[8:11], s54 offen sc1 lds
    s_add_u32 s54, s54, 55296
    s_add_u32 s55, s55, 1024
    s_mov_b32 m0, s55
    s_nop 0
    buffer_load_dwordx4 v4, s[8:11], s54 offen sc1 lds
    s_add_u32 s54, s54, 55296
    s_add_u32 s55, s55, 1024
    s_mov_b32 s52, 7
    s_lshr_b32 s53, s52, 1
    s_and_b32 s54, s52, 1
    s_mul_i32 s54, s54, 27
    s_add_u32 s54, s54, s53
    s_mul_i32 s55, s7, 270
    s_add_u32 s54, s54, s55
    s_lshl_b32 s54, s54, 10
    s_add_u32 s54, s54, 30490624
    s_mul_i32 s55, s52, 5120
    s_mov_b32 m0, s55
    s_nop 0
    buffer_load_dwordx4 v4, s[8:11], s54 offen sc1 lds
    s_add_u32 s54, s54, 55296
    s_add_u32 s55, s55, 1024
    s_mov_b32 m0, s55
    s_nop 0
    buffer_load_dwordx4 v4, s[8:11], s54 offen sc1 lds
    s_add_u32 s54, s54, 55296
    s_add_u32 s55, s55, 1024
    s_mov_b32 m0, s55
    s_nop 0
    buffer_load_dwordx4 v4, s[8:11], s54 offen sc1 lds
    s_add_u32 s54, s54, 55296
    s_add_u32 s55, s55, 1024
    s_mov_b32 m0, s55
    s_nop 0
    buffer_load_dwordx4 v4, s[8:11], s54 offen sc1 lds
    s_add_u32 s54, s54, 55296
    s_add_u32 s55, s55, 1024
    s_mov_b32 m0, s55
    s_nop 0
    buffer_load_dwordx4 v4, s[8:11], s54 offen sc1 lds
    s_add_u32 s54, s54, 55296
    s_add_u32 s55, s55, 1024
    s_mov_b32 s52, 15
    s_lshr_b32 s53, s52, 1
    s_and_b32 s54, s52, 1
    s_mul_i32 s54, s54, 27
    s_add_u32 s54, s54, s53
    s_mul_i32 s55, s7, 270
    s_add_u32 s54, s54, s55
    s_lshl_b32 s54, s54, 10
    s_add_u32 s54, s54, 30490624
    s_mul_i32 s55, s52, 5120
    s_mov_b32 m0, s55
    s_nop 0
    buffer_load_dwordx4 v4, s[8:11], s54 offen sc1 lds
    s_add_u32 s54, s54, 55296
    s_add_u32 s55, s55, 1024
    s_mov_b32 m0, s55
    s_nop 0
    buffer_load_dwordx4 v4, s[8:11], s54 offen sc1 lds
    s_add_u32 s54, s54, 55296
    s_add_u32 s55, s55, 1024
    s_mov_b32 m0, s55
    s_nop 0
    buffer_load_dwordx4 v4, s[8:11], s54 offen sc1 lds
    s_add_u32 s54, s54, 55296
    s_add_u32 s55, s55, 1024
    s_mov_b32 m0, s55
    s_nop 0
    buffer_load_dwordx4 v4, s[8:11], s54 offen sc1 lds
    s_add_u32 s54, s54, 55296
    s_add_u32 s55, s55, 1024
    s_mov_b32 m0, s55
    s_nop 0
    buffer_load_dwordx4 v4, s[8:11], s54 offen sc1 lds
    s_add_u32 s54, s54, 55296
    s_add_u32 s55, s55, 1024
    s_cmp_eq_u32 s41, 7
    s_cbranch_scc1 interleave_layers__grouped_kv_mqa__mixer_channel_mlp__prompt_kernel_fin84
    s_mov_b32 s52, 14
    s_lshr_b32 s53, s52, 1
    s_and_b32 s54, s52, 1
    s_mul_i32 s54, s54, 27
    s_add_u32 s54, s54, s53
    s_mul_i32 s55, s7, 270
    s_add_u32 s54, s54, s55
    s_lshl_b32 s54, s54, 10
    s_add_u32 s54, s54, 30490624
    s_mul_i32 s55, s52, 5120
    s_mov_b32 m0, s55
    s_nop 0
    buffer_load_dwordx4 v4, s[8:11], s54 offen sc1 lds
    s_add_u32 s54, s54, 55296
    s_add_u32 s55, s55, 1024
    s_mov_b32 m0, s55
    s_nop 0
    buffer_load_dwordx4 v4, s[8:11], s54 offen sc1 lds
    s_add_u32 s54, s54, 55296
    s_add_u32 s55, s55, 1024
    s_mov_b32 m0, s55
    s_nop 0
    buffer_load_dwordx4 v4, s[8:11], s54 offen sc1 lds
    s_add_u32 s54, s54, 55296
    s_add_u32 s55, s55, 1024
    s_mov_b32 m0, s55
    s_nop 0
    buffer_load_dwordx4 v4, s[8:11], s54 offen sc1 lds
    s_add_u32 s54, s54, 55296
    s_add_u32 s55, s55, 1024
    s_mov_b32 m0, s55
    s_nop 0
    buffer_load_dwordx4 v4, s[8:11], s54 offen sc1 lds
    s_add_u32 s54, s54, 55296
    s_add_u32 s55, s55, 1024
    s_branch interleave_layers__grouped_kv_mqa__mixer_channel_mlp__prompt_kernel_fin84
interleave_layers__grouped_kv_mqa__mixer_channel_mlp__prompt_kernel_act83:
    s_mov_b32 s16, s78
    s_mov_b32 s17, s79
    s_and_b32 s17, s17, 0xffff
    s_mov_b32 s18, 3456
    s_mov_b32 s19, 0x20000
    s_lshl_b32 s28, s40, 6
    v_lshl_add_u32 v90, v6, 3, s28
    buffer_load_dwordx2 v[72:73], v90, s[16:19], 0 offen offset:0
    buffer_load_dwordx2 v[74:75], v90, s[16:19], 0 offen offset:16
    buffer_load_dwordx2 v[76:77], v90, s[16:19], 0 offen offset:32
    buffer_load_dwordx2 v[78:79], v90, s[16:19], 0 offen offset:48
    s_waitcnt vmcnt(9)
    s_barrier
    v_lshrrev_b32 v90, 4, v5
    v_mul_u32_u24 v90, 20480, v90
    v_lshl_add_u32 v90, v6, 8, v90
    v_lshl_add_u32 v90, v2, 4, v90
    v_mov_b32 v89, 0x3f803f80
    v_mov_b32 v88, 0
    s_cmp_lg_u32 s12, 0
    s_cselect_b64 vcc, -1, 0
    s_cbranch_vccnz interleave_layers__grouped_kv_mqa__mixer_channel_mlp__prompt_kernel_p187
    ds_read_b128 v[56:59], v90 offset:0
    ds_read_b128 v[60:63], v90 offset:512
    ds_read_b128 v[64:67], v90 offset:1024
    buffer_load_dwordx4 v[144:147], v4, s[8:11], s42 offen offset:0 sc1
    ds_read_b128 v[68:71], v90 offset:1536
    s_waitcnt lgkmcnt(3)
    v_mfma_f32_32x32x16_bf16 v[24:39], v[208:211], v[56:59], 0
    v_dot2c_f32_bf16 v88, v208, v89
    v_dot2c_f32_bf16 v88, v209, v89
    v_dot2c_f32_bf16 v88, v210, v89
    v_dot2c_f32_bf16 v88, v211, v89
    buffer_load_dwordx4 v[148:151], v4, s[8:11], s42 offen offset:1024 sc1
    ds_read_b128 v[56:59], v90 offset:2048
    s_waitcnt lgkmcnt(3)
    v_mfma_f32_32x32x16_bf16 v[24:39], v[212:215], v[60:63], v[24:39]
    v_dot2c_f32_bf16 v88, v212, v89
    v_dot2c_f32_bf16 v88, v213, v89
    v_dot2c_f32_bf16 v88, v214, v89
    v_dot2c_f32_bf16 v88, v215, v89
    buffer_load_dwordx4 v[152:155], v4, s[8:11], s42 offen offset:2048 sc1
    ds_read_b128 v[60:63], v90 offset:2560
    s_waitcnt lgkmcnt(3)
    v_mfma_f32_32x32x16_bf16 v[24:39], v[216:219], v[64:67], v[24:39]
    v_dot2c_f32_bf16 v88, v216, v89
    v_dot2c_f32_bf16 v88, v217, v89
    v_dot2c_f32_bf16 v88, v218, v89
    v_dot2c_f32_bf16 v88, v219, v89
    buffer_load_dwordx4 v[156:159], v4, s[8:11], s42 offen offset:3072 sc1
    s_add_u32 s42, s42, 4096
    ds_read_b128 v[64:67], v90 offset:3072
    s_waitcnt lgkmcnt(3)
    v_mfma_f32_32x32x16_bf16 v[24:39], v[220:223], v[68:71], v[24:39]
    v_dot2c_f32_bf16 v88, v220, v89
    v_dot2c_f32_bf16 v88, v221, v89
    v_dot2c_f32_bf16 v88, v222, v89
    v_dot2c_f32_bf16 v88, v223, v89
    buffer_load_dwordx4 v[160:163], v4, s[8:11], s42 offen offset:0 sc1
    ds_read_b128 v[68:71], v90 offset:3584
    s_waitcnt lgkmcnt(3)
    v_mfma_f32_32x32x16_bf16 v[24:39], v[224:227], v[56:59], v[24:39]
    v_dot2c_f32_bf16 v88, v224, v89
    v_dot2c_f32_bf16 v88, v225, v89
    v_dot2c_f32_bf16 v88, v226, v89
    v_dot2c_f32_bf16 v88, v227, v89
    buffer_load_dwordx4 v[164:167], v4, s[8:11], s42 offen offset:1024 sc1
    ds_read_b128 v[56:59], v90 offset:4096
    s_waitcnt lgkmcnt(3)
    v_mfma_f32_32x32x16_bf16 v[24:39], v[228:231], v[60:63], v[24:39]
    v_dot2c_f32_bf16 v88, v228, v89
    v_dot2c_f32_bf16 v88, v229, v89
    v_dot2c_f32_bf16 v88, v230, v89
    v_dot2c_f32_bf16 v88, v231, v89
    buffer_load_dwordx4 v[168:171], v4, s[8:11], s42 offen offset:2048 sc1
    ds_read_b128 v[60:63], v90 offset:4608
    s_waitcnt lgkmcnt(3)
    v_mfma_f32_32x32x16_bf16 v[24:39], v[232:235], v[64:67], v[24:39]
    v_dot2c_f32_bf16 v88, v232, v89
    v_dot2c_f32_bf16 v88, v233, v89
    v_dot2c_f32_bf16 v88, v234, v89
    v_dot2c_f32_bf16 v88, v235, v89
    buffer_load_dwordx4 v[172:175], v4, s[8:11], s42 offen offset:3072 sc1
    s_add_u32 s42, s42, 4096
    ds_read_b128 v[64:67], v90 offset:5120
    s_waitcnt lgkmcnt(3)
    v_mfma_f32_32x32x16_bf16 v[24:39], v[236:239], v[68:71], v[24:39]
    v_dot2c_f32_bf16 v88, v236, v89
    v_dot2c_f32_bf16 v88, v237, v89
    v_dot2c_f32_bf16 v88, v238, v89
    v_dot2c_f32_bf16 v88, v239, v89
    buffer_load_dwordx4 v[176:179], v4, s[8:11], s42 offen offset:0 sc1
    ds_read_b128 v[68:71], v90 offset:5632
    s_waitcnt lgkmcnt(3)
    v_mfma_f32_32x32x16_bf16 v[24:39], v[240:243], v[56:59], v[24:39]
    v_dot2c_f32_bf16 v88, v240, v89
    v_dot2c_f32_bf16 v88, v241, v89
    v_dot2c_f32_bf16 v88, v242, v89
    v_dot2c_f32_bf16 v88, v243, v89
    buffer_load_dwordx4 v[180:183], v4, s[8:11], s42 offen offset:1024 sc1
    ds_read_b128 v[56:59], v90 offset:6144
    s_waitcnt lgkmcnt(3)
    v_mfma_f32_32x32x16_bf16 v[24:39], v[244:247], v[60:63], v[24:39]
    v_dot2c_f32_bf16 v88, v244, v89
    v_dot2c_f32_bf16 v88, v245, v89
    v_dot2c_f32_bf16 v88, v246, v89
    v_dot2c_f32_bf16 v88, v247, v89
    buffer_load_dwordx4 v[184:187], v4, s[8:11], s42 offen offset:2048 sc1
    ds_read_b128 v[60:63], v90 offset:6656
    s_waitcnt lgkmcnt(3)
    v_mfma_f32_32x32x16_bf16 v[24:39], v[248:251], v[64:67], v[24:39]
    v_dot2c_f32_bf16 v88, v248, v89
    v_dot2c_f32_bf16 v88, v249, v89
    v_dot2c_f32_bf16 v88, v250, v89
    v_dot2c_f32_bf16 v88, v251, v89
    buffer_load_dwordx4 v[188:191], v4, s[8:11], s42 offen offset:3072 sc1
    s_add_u32 s42, s42, 4096
    ds_read_b128 v[64:67], v90 offset:7168
    s_waitcnt lgkmcnt(3)
    v_mfma_f32_32x32x16_bf16 v[24:39], v[252:255], v[68:71], v[24:39]
    v_dot2c_f32_bf16 v88, v252, v89
    v_dot2c_f32_bf16 v88, v253, v89
    v_dot2c_f32_bf16 v88, v254, v89
    v_dot2c_f32_bf16 v88, v255, v89
    buffer_load_dwordx4 v[192:195], v4, s[8:11], s42 offen offset:0 sc1
    ds_read_b128 v[68:71], v90 offset:7680
    s_waitcnt lgkmcnt(3)
    v_mfma_f32_32x32x16_bf16 v[24:39], v[96:99], v[56:59], v[24:39]
    v_dot2c_f32_bf16 v88, v96, v89
    v_dot2c_f32_bf16 v88, v97, v89
    v_dot2c_f32_bf16 v88, v98, v89
    v_dot2c_f32_bf16 v88, v99, v89
    buffer_load_dwordx4 v[196:199], v4, s[8:11], s42 offen offset:1024 sc1
    ds_read_b128 v[56:59], v90 offset:8192
    s_waitcnt lgkmcnt(3)
    v_mfma_f32_32x32x16_bf16 v[24:39], v[100:103], v[60:63], v[24:39]
    v_dot2c_f32_bf16 v88, v100, v89
    v_dot2c_f32_bf16 v88, v101, v89
    v_dot2c_f32_bf16 v88, v102, v89
    v_dot2c_f32_bf16 v88, v103, v89
    buffer_load_dwordx4 v[200:203], v4, s[8:11], s42 offen offset:2048 sc1
    ds_read_b128 v[60:63], v90 offset:8704
    s_waitcnt lgkmcnt(3)
    v_mfma_f32_32x32x16_bf16 v[24:39], v[104:107], v[64:67], v[24:39]
    v_dot2c_f32_bf16 v88, v104, v89
    v_dot2c_f32_bf16 v88, v105, v89
    v_dot2c_f32_bf16 v88, v106, v89
    v_dot2c_f32_bf16 v88, v107, v89
    buffer_load_dwordx4 v[204:207], v4, s[8:11], s42 offen offset:3072 sc1
    s_add_u32 s42, s42, 4096
    ds_read_b128 v[64:67], v90 offset:9216
    s_waitcnt lgkmcnt(3)
    v_mfma_f32_32x32x16_bf16 v[24:39], v[108:111], v[68:71], v[24:39]
    v_dot2c_f32_bf16 v88, v108, v89
    v_dot2c_f32_bf16 v88, v109, v89
    v_dot2c_f32_bf16 v88, v110, v89
    v_dot2c_f32_bf16 v88, v111, v89
    ds_read_b128 v[68:71], v90 offset:9728
    s_waitcnt lgkmcnt(3)
    v_mfma_f32_32x32x16_bf16 v[24:39], v[112:115], v[56:59], v[24:39]
    v_dot2c_f32_bf16 v88, v112, v89
    v_dot2c_f32_bf16 v88, v113, v89
    v_dot2c_f32_bf16 v88, v114, v89
    v_dot2c_f32_bf16 v88, v115, v89
    ds_read_b128 v[56:59], v90 offset:10240
    s_waitcnt lgkmcnt(3)
    v_mfma_f32_32x32x16_bf16 v[24:39], v[116:119], v[60:63], v[24:39]
    v_dot2c_f32_bf16 v88, v116, v89
    v_dot2c_f32_bf16 v88, v117, v89
    v_dot2c_f32_bf16 v88, v118, v89
    v_dot2c_f32_bf16 v88, v119, v89
    ds_read_b128 v[60:63], v90 offset:10752
    s_waitcnt lgkmcnt(3)
    v_mfma_f32_32x32x16_bf16 v[24:39], v[120:123], v[64:67], v[24:39]
    v_dot2c_f32_bf16 v88, v120, v89
    v_dot2c_f32_bf16 v88, v121, v89
    v_dot2c_f32_bf16 v88, v122, v89
    v_dot2c_f32_bf16 v88, v123, v89
    ds_read_b128 v[64:67], v90 offset:11264
    s_waitcnt lgkmcnt(3)
    v_mfma_f32_32x32x16_bf16 v[24:39], v[124:127], v[68:71], v[24:39]
    v_dot2c_f32_bf16 v88, v124, v89
    v_dot2c_f32_bf16 v88, v125, v89
    v_dot2c_f32_bf16 v88, v126, v89
    v_dot2c_f32_bf16 v88, v127, v89
    ds_read_b128 v[68:71], v90 offset:11776
    s_waitcnt lgkmcnt(3)
    v_mfma_f32_32x32x16_bf16 v[24:39], v[128:131], v[56:59], v[24:39]
    v_dot2c_f32_bf16 v88, v128, v89
    v_dot2c_f32_bf16 v88, v129, v89
    v_dot2c_f32_bf16 v88, v130, v89
    v_dot2c_f32_bf16 v88, v131, v89
    ds_read_b128 v[56:59], v90 offset:12288
    s_waitcnt lgkmcnt(3)
    v_mfma_f32_32x32x16_bf16 v[24:39], v[132:135], v[60:63], v[24:39]
    v_dot2c_f32_bf16 v88, v132, v89
    v_dot2c_f32_bf16 v88, v133, v89
    v_dot2c_f32_bf16 v88, v134, v89
    v_dot2c_f32_bf16 v88, v135, v89
    ds_read_b128 v[60:63], v90 offset:12800
    s_waitcnt lgkmcnt(3)
    v_mfma_f32_32x32x16_bf16 v[24:39], v[136:139], v[64:67], v[24:39]
    v_dot2c_f32_bf16 v88, v136, v89
    v_dot2c_f32_bf16 v88, v137, v89
    v_dot2c_f32_bf16 v88, v138, v89
    v_dot2c_f32_bf16 v88, v139, v89
    ds_read_b128 v[64:67], v90 offset:13312
    s_waitcnt lgkmcnt(3)
    v_mfma_f32_32x32x16_bf16 v[24:39], v[140:143], v[68:71], v[24:39]
    v_dot2c_f32_bf16 v88, v140, v89
    v_dot2c_f32_bf16 v88, v141, v89
    v_dot2c_f32_bf16 v88, v142, v89
    v_dot2c_f32_bf16 v88, v143, v89
    ds_read_b128 v[68:71], v90 offset:13824
    s_waitcnt lgkmcnt(3) vmcnt(15)
    v_mfma_f32_32x32x16_bf16 v[24:39], v[144:147], v[56:59], v[24:39]
    v_dot2c_f32_bf16 v88, v144, v89
    v_dot2c_f32_bf16 v88, v145, v89
    v_dot2c_f32_bf16 v88, v146, v89
    v_dot2c_f32_bf16 v88, v147, v89
    ds_read_b128 v[56:59], v90 offset:14336
    s_waitcnt lgkmcnt(3) vmcnt(14)
    v_mfma_f32_32x32x16_bf16 v[24:39], v[148:151], v[60:63], v[24:39]
    v_dot2c_f32_bf16 v88, v148, v89
    v_dot2c_f32_bf16 v88, v149, v89
    v_dot2c_f32_bf16 v88, v150, v89
    v_dot2c_f32_bf16 v88, v151, v89
    ds_read_b128 v[60:63], v90 offset:14848
    s_waitcnt lgkmcnt(3) vmcnt(13)
    v_mfma_f32_32x32x16_bf16 v[24:39], v[152:155], v[64:67], v[24:39]
    v_dot2c_f32_bf16 v88, v152, v89
    v_dot2c_f32_bf16 v88, v153, v89
    v_dot2c_f32_bf16 v88, v154, v89
    v_dot2c_f32_bf16 v88, v155, v89
    ds_read_b128 v[64:67], v90 offset:15360
    s_waitcnt lgkmcnt(3) vmcnt(12)
    v_mfma_f32_32x32x16_bf16 v[24:39], v[156:159], v[68:71], v[24:39]
    v_dot2c_f32_bf16 v88, v156, v89
    v_dot2c_f32_bf16 v88, v157, v89
    v_dot2c_f32_bf16 v88, v158, v89
    v_dot2c_f32_bf16 v88, v159, v89
    ds_read_b128 v[68:71], v90 offset:15872
    s_waitcnt lgkmcnt(3) vmcnt(11)
    v_mfma_f32_32x32x16_bf16 v[24:39], v[160:163], v[56:59], v[24:39]
    v_dot2c_f32_bf16 v88, v160, v89
    v_dot2c_f32_bf16 v88, v161, v89
    v_dot2c_f32_bf16 v88, v162, v89
    v_dot2c_f32_bf16 v88, v163, v89
    ds_read_b128 v[56:59], v90 offset:16384
    s_waitcnt lgkmcnt(3) vmcnt(10)
    v_mfma_f32_32x32x16_bf16 v[24:39], v[164:167], v[60:63], v[24:39]
    v_dot2c_f32_bf16 v88, v164, v89
    v_dot2c_f32_bf16 v88, v165, v89
    v_dot2c_f32_bf16 v88, v166, v89
    v_dot2c_f32_bf16 v88, v167, v89
    ds_read_b128 v[60:63], v90 offset:16896
    s_waitcnt lgkmcnt(3) vmcnt(9)
    v_mfma_f32_32x32x16_bf16 v[24:39], v[168:171], v[64:67], v[24:39]
    v_dot2c_f32_bf16 v88, v168, v89
    v_dot2c_f32_bf16 v88, v169, v89
    v_dot2c_f32_bf16 v88, v170, v89
    v_dot2c_f32_bf16 v88, v171, v89
    ds_read_b128 v[64:67], v90 offset:17408
    s_waitcnt lgkmcnt(3) vmcnt(8)
    v_mfma_f32_32x32x16_bf16 v[24:39], v[172:175], v[68:71], v[24:39]
    v_dot2c_f32_bf16 v88, v172, v89
    v_dot2c_f32_bf16 v88, v173, v89
    v_dot2c_f32_bf16 v88, v174, v89
    v_dot2c_f32_bf16 v88, v175, v89
    ds_read_b128 v[68:71], v90 offset:17920
    s_waitcnt lgkmcnt(3) vmcnt(7)
    v_mfma_f32_32x32x16_bf16 v[24:39], v[176:179], v[56:59], v[24:39]
    v_dot2c_f32_bf16 v88, v176, v89
    v_dot2c_f32_bf16 v88, v177, v89
    v_dot2c_f32_bf16 v88, v178, v89
    v_dot2c_f32_bf16 v88, v179, v89
    ds_read_b128 v[56:59], v90 offset:18432
    s_waitcnt lgkmcnt(3) vmcnt(6)
    v_mfma_f32_32x32x16_bf16 v[24:39], v[180:183], v[60:63], v[24:39]
    v_dot2c_f32_bf16 v88, v180, v89
    v_dot2c_f32_bf16 v88, v181, v89
    v_dot2c_f32_bf16 v88, v182, v89
    v_dot2c_f32_bf16 v88, v183, v89
    ds_read_b128 v[60:63], v90 offset:18944
    s_waitcnt lgkmcnt(3) vmcnt(5)
    v_mfma_f32_32x32x16_bf16 v[24:39], v[184:187], v[64:67], v[24:39]
    v_dot2c_f32_bf16 v88, v184, v89
    v_dot2c_f32_bf16 v88, v185, v89
    v_dot2c_f32_bf16 v88, v186, v89
    v_dot2c_f32_bf16 v88, v187, v89
    ds_read_b128 v[64:67], v90 offset:19456
    s_waitcnt lgkmcnt(3) vmcnt(4)
    v_mfma_f32_32x32x16_bf16 v[24:39], v[188:191], v[68:71], v[24:39]
    v_dot2c_f32_bf16 v88, v188, v89
    v_dot2c_f32_bf16 v88, v189, v89
    v_dot2c_f32_bf16 v88, v190, v89
    v_dot2c_f32_bf16 v88, v191, v89
    ds_read_b128 v[68:71], v90 offset:19968
    s_waitcnt lgkmcnt(3) vmcnt(3)
    v_mfma_f32_32x32x16_bf16 v[24:39], v[192:195], v[56:59], v[24:39]
    v_dot2c_f32_bf16 v88, v192, v89
    v_dot2c_f32_bf16 v88, v193, v89
    v_dot2c_f32_bf16 v88, v194, v89
    v_dot2c_f32_bf16 v88, v195, v89
    s_waitcnt lgkmcnt(2) vmcnt(2)
    v_mfma_f32_32x32x16_bf16 v[24:39], v[196:199], v[60:63], v[24:39]
    v_dot2c_f32_bf16 v88, v196, v89
    v_dot2c_f32_bf16 v88, v197, v89
    v_dot2c_f32_bf16 v88, v198, v89
    v_dot2c_f32_bf16 v88, v199, v89
    s_waitcnt lgkmcnt(1) vmcnt(1)
    v_mfma_f32_32x32x16_bf16 v[24:39], v[200:203], v[64:67], v[24:39]
    v_dot2c_f32_bf16 v88, v200, v89
    v_dot2c_f32_bf16 v88, v201, v89
    v_dot2c_f32_bf16 v88, v202, v89
    v_dot2c_f32_bf16 v88, v203, v89
    s_waitcnt lgkmcnt(0) vmcnt(0)
    v_mfma_f32_32x32x16_bf16 v[24:39], v[204:207], v[68:71], v[24:39]
    v_dot2c_f32_bf16 v88, v204, v89
    v_dot2c_f32_bf16 v88, v205, v89
    v_dot2c_f32_bf16 v88, v206, v89
    v_dot2c_f32_bf16 v88, v207, v89
    s_branch interleave_layers__grouped_kv_mqa__mixer_channel_mlp__prompt_kernel_p1d88
interleave_layers__grouped_kv_mqa__mixer_channel_mlp__prompt_kernel_p187:
    ds_read_b128 v[56:59], v90 offset:0
    ds_read_b128 v[60:63], v90 offset:512
    ds_read_b128 v[64:67], v90 offset:1024
    buffer_load_dwordx4 v[144:147], v4, s[8:11], s42 offen offset:0 sc1
    ds_read_b128 v[68:71], v90 offset:1536
    s_waitcnt lgkmcnt(3)
    v_mfma_f32_32x32x16_bf16 v[24:39], v[208:211], v[56:59], 0
    buffer_load_dwordx4 v[148:151], v4, s[8:11], s42 offen offset:1024 sc1
    ds_read_b128 v[56:59], v90 offset:2048
    s_waitcnt lgkmcnt(3)
    v_mfma_f32_32x32x16_bf16 v[24:39], v[212:215], v[60:63], v[24:39]
    buffer_load_dwordx4 v[152:155], v4, s[8:11], s42 offen offset:2048 sc1
    ds_read_b128 v[60:63], v90 offset:2560
    s_waitcnt lgkmcnt(3)
    v_mfma_f32_32x32x16_bf16 v[24:39], v[216:219], v[64:67], v[24:39]
    buffer_load_dwordx4 v[156:159], v4, s[8:11], s42 offen offset:3072 sc1
    s_add_u32 s42, s42, 4096
    ds_read_b128 v[64:67], v90 offset:3072
    s_waitcnt lgkmcnt(3)
    v_mfma_f32_32x32x16_bf16 v[24:39], v[220:223], v[68:71], v[24:39]
    buffer_load_dwordx4 v[160:163], v4, s[8:11], s42 offen offset:0 sc1
    ds_read_b128 v[68:71], v90 offset:3584
    s_waitcnt lgkmcnt(3)
    v_mfma_f32_32x32x16_bf16 v[24:39], v[224:227], v[56:59], v[24:39]
    buffer_load_dwordx4 v[164:167], v4, s[8:11], s42 offen offset:1024 sc1
    ds_read_b128 v[56:59], v90 offset:4096
    s_waitcnt lgkmcnt(3)
    v_mfma_f32_32x32x16_bf16 v[24:39], v[228:231], v[60:63], v[24:39]
    buffer_load_dwordx4 v[168:171], v4, s[8:11], s42 offen offset:2048 sc1
    ds_read_b128 v[60:63], v90 offset:4608
    s_waitcnt lgkmcnt(3)
    v_mfma_f32_32x32x16_bf16 v[24:39], v[232:235], v[64:67], v[24:39]
    buffer_load_dwordx4 v[172:175], v4, s[8:11], s42 offen offset:3072 sc1
    s_add_u32 s42, s42, 4096
    ds_read_b128 v[64:67], v90 offset:5120
    s_waitcnt lgkmcnt(3)
    v_mfma_f32_32x32x16_bf16 v[24:39], v[236:239], v[68:71], v[24:39]
    buffer_load_dwordx4 v[176:179], v4, s[8:11], s42 offen offset:0 sc1
    ds_read_b128 v[68:71], v90 offset:5632
    s_waitcnt lgkmcnt(3)
    v_mfma_f32_32x32x16_bf16 v[24:39], v[240:243], v[56:59], v[24:39]
    buffer_load_dwordx4 v[180:183], v4, s[8:11], s42 offen offset:1024 sc1
    ds_read_b128 v[56:59], v90 offset:6144
    s_waitcnt lgkmcnt(3)
    v_mfma_f32_32x32x16_bf16 v[24:39], v[244:247], v[60:63], v[24:39]
    buffer_load_dwordx4 v[184:187], v4, s[8:11], s42 offen offset:2048 sc1
    ds_read_b128 v[60:63], v90 offset:6656
    s_waitcnt lgkmcnt(3)
    v_mfma_f32_32x32x16_bf16 v[24:39], v[248:251], v[64:67], v[24:39]
    buffer_load_dwordx4 v[188:191], v4, s[8:11], s42 offen offset:3072 sc1
    s_add_u32 s42, s42, 4096
    ds_read_b128 v[64:67], v90 offset:7168
    s_waitcnt lgkmcnt(3)
    v_mfma_f32_32x32x16_bf16 v[24:39], v[252:255], v[68:71], v[24:39]
    buffer_load_dwordx4 v[192:195], v4, s[8:11], s42 offen offset:0 sc1
    ds_read_b128 v[68:71], v90 offset:7680
    s_waitcnt lgkmcnt(3)
    v_mfma_f32_32x32x16_bf16 v[24:39], v[96:99], v[56:59], v[24:39]
    buffer_load_dwordx4 v[196:199], v4, s[8:11], s42 offen offset:1024 sc1
    ds_read_b128 v[56:59], v90 offset:8192
    s_waitcnt lgkmcnt(3)
    v_mfma_f32_32x32x16_bf16 v[24:39], v[100:103], v[60:63], v[24:39]
    buffer_load_dwordx4 v[200:203], v4, s[8:11], s42 offen offset:2048 sc1
    ds_read_b128 v[60:63], v90 offset:8704
    s_waitcnt lgkmcnt(3)
    v_mfma_f32_32x32x16_bf16 v[24:39], v[104:107], v[64:67], v[24:39]
    buffer_load_dwordx4 v[204:207], v4, s[8:11], s42 offen offset:3072 sc1
    s_add_u32 s42, s42, 4096
    ds_read_b128 v[64:67], v90 offset:9216
    s_waitcnt lgkmcnt(3)
    v_mfma_f32_32x32x16_bf16 v[24:39], v[108:111], v[68:71], v[24:39]
    ds_read_b128 v[68:71], v90 offset:9728
    s_waitcnt lgkmcnt(3)
    v_mfma_f32_32x32x16_bf16 v[24:39], v[112:115], v[56:59], v[24:39]
    ds_read_b128 v[56:59], v90 offset:10240
    s_waitcnt lgkmcnt(3)
    v_mfma_f32_32x32x16_bf16 v[24:39], v[116:119], v[60:63], v[24:39]
    ds_read_b128 v[60:63], v90 offset:10752
    s_waitcnt lgkmcnt(3)
    v_mfma_f32_32x32x16_bf16 v[24:39], v[120:123], v[64:67], v[24:39]
    ds_read_b128 v[64:67], v90 offset:11264
    s_waitcnt lgkmcnt(3)
    v_mfma_f32_32x32x16_bf16 v[24:39], v[124:127], v[68:71], v[24:39]
    ds_read_b128 v[68:71], v90 offset:11776
    s_waitcnt lgkmcnt(3)
    v_mfma_f32_32x32x16_bf16 v[24:39], v[128:131], v[56:59], v[24:39]
    ds_read_b128 v[56:59], v90 offset:12288
    s_waitcnt lgkmcnt(3)
    v_mfma_f32_32x32x16_bf16 v[24:39], v[132:135], v[60:63], v[24:39]
    ds_read_b128 v[60:63], v90 offset:12800
    s_waitcnt lgkmcnt(3)
    v_mfma_f32_32x32x16_bf16 v[24:39], v[136:139], v[64:67], v[24:39]
    ds_read_b128 v[64:67], v90 offset:13312
    s_waitcnt lgkmcnt(3)
    v_mfma_f32_32x32x16_bf16 v[24:39], v[140:143], v[68:71], v[24:39]
    ds_read_b128 v[68:71], v90 offset:13824
    s_waitcnt lgkmcnt(3) vmcnt(15)
    v_mfma_f32_32x32x16_bf16 v[24:39], v[144:147], v[56:59], v[24:39]
    ds_read_b128 v[56:59], v90 offset:14336
    s_waitcnt lgkmcnt(3) vmcnt(14)
    v_mfma_f32_32x32x16_bf16 v[24:39], v[148:151], v[60:63], v[24:39]
    ds_read_b128 v[60:63], v90 offset:14848
    s_waitcnt lgkmcnt(3) vmcnt(13)
    v_mfma_f32_32x32x16_bf16 v[24:39], v[152:155], v[64:67], v[24:39]
    ds_read_b128 v[64:67], v90 offset:15360
    s_waitcnt lgkmcnt(3) vmcnt(12)
    v_mfma_f32_32x32x16_bf16 v[24:39], v[156:159], v[68:71], v[24:39]
    ds_read_b128 v[68:71], v90 offset:15872
    s_waitcnt lgkmcnt(3) vmcnt(11)
    v_mfma_f32_32x32x16_bf16 v[24:39], v[160:163], v[56:59], v[24:39]
    ds_read_b128 v[56:59], v90 offset:16384
    s_waitcnt lgkmcnt(3) vmcnt(10)
    v_mfma_f32_32x32x16_bf16 v[24:39], v[164:167], v[60:63], v[24:39]
    ds_read_b128 v[60:63], v90 offset:16896
    s_waitcnt lgkmcnt(3) vmcnt(9)
    v_mfma_f32_32x32x16_bf16 v[24:39], v[168:171], v[64:67], v[24:39]
    ds_read_b128 v[64:67], v90 offset:17408
    s_waitcnt lgkmcnt(3) vmcnt(8)
    v_mfma_f32_32x32x16_bf16 v[24:39], v[172:175], v[68:71], v[24:39]
    ds_read_b128 v[68:71], v90 offset:17920
    s_waitcnt lgkmcnt(3) vmcnt(7)
    v_mfma_f32_32x32x16_bf16 v[24:39], v[176:179], v[56:59], v[24:39]
    ds_read_b128 v[56:59], v90 offset:18432
    s_waitcnt lgkmcnt(3) vmcnt(6)
    v_mfma_f32_32x32x16_bf16 v[24:39], v[180:183], v[60:63], v[24:39]
    ds_read_b128 v[60:63], v90 offset:18944
    s_waitcnt lgkmcnt(3) vmcnt(5)
    v_mfma_f32_32x32x16_bf16 v[24:39], v[184:187], v[64:67], v[24:39]
    ds_read_b128 v[64:67], v90 offset:19456
    s_waitcnt lgkmcnt(3) vmcnt(4)
    v_mfma_f32_32x32x16_bf16 v[24:39], v[188:191], v[68:71], v[24:39]
    ds_read_b128 v[68:71], v90 offset:19968
    s_waitcnt lgkmcnt(3) vmcnt(3)
    v_mfma_f32_32x32x16_bf16 v[24:39], v[192:195], v[56:59], v[24:39]
    s_waitcnt lgkmcnt(2) vmcnt(2)
    v_mfma_f32_32x32x16_bf16 v[24:39], v[196:199], v[60:63], v[24:39]
    s_waitcnt lgkmcnt(1) vmcnt(1)
    v_mfma_f32_32x32x16_bf16 v[24:39], v[200:203], v[64:67], v[24:39]
    s_waitcnt lgkmcnt(0) vmcnt(0)
    v_mfma_f32_32x32x16_bf16 v[24:39], v[204:207], v[68:71], v[24:39]
interleave_layers__grouped_kv_mqa__mixer_channel_mlp__prompt_kernel_p1d88:
    s_cbranch_vccnz interleave_layers__grouped_kv_mqa__mixer_channel_mlp__prompt_kernel_ncs89
    s_nop 0
    v_mov_b32 v91, v88
    s_nop 1
    v_permlane32_swap_b32 v88, v91
    v_add_f32 v88, v88, v91
    s_lshl_b32 s28, s3, 7
    s_add_u32 s28, s28, 154112
    v_lshl_add_u32 v91, v5, 2, s28
    ds_write_b32 v91, v88
interleave_layers__grouped_kv_mqa__mixer_channel_mlp__prompt_kernel_ncs89:
    s_waitcnt vmcnt(0) lgkmcnt(0)
    s_barrier
    v_mov_b32 v84, 0xc0135761
    v_mov_b32 v86, 0xbdd2d3e8
    v_mov_b32 v85, 0xc0135761
    v_mov_b32 v87, 0xbdd2d3e8
    v_mov_b32 v92, 1.0
    v_mov_b32 v93, 1.0
    v_lshlrev_b32 v94, 3, v5
    v_add_u32 v94, 153600, v94
    ds_read_b64 v[80:81], v94
    ds_read_b64 v[82:83], v94 offset:256
    v_lshrrev_b32 v95, 4, v5
    s_mov_b32 s28, 55296
    v_mul_lo_u32 v95, v95, s28
    v_lshl_add_u32 v95, v6, 3, v95
    v_lshl_add_u32 v95, v2, 4, v95
    s_lshl_b32 s28, s6, 2
    s_add_u32 s28, s28, 0
    s_mul_i32 s28, s28, 54
    s_add_u32 s28, s28, s40
    s_lshl_b32 s28, s28, 10
    s_mul_i32 s29, s12, 7077888
    s_add_u32 s28, s28, s29
    s_add_u32 s56, s28, 11501568
    s_lshl_b32 s28, s6, 2
    s_add_u32 s28, s28, 2
    s_mul_i32 s28, s28, 54
    s_add_u32 s28, s28, s40
    s_lshl_b32 s28, s28, 10
    s_mul_i32 s29, s12, 7077888
    s_add_u32 s28, s28, s29
    s_add_u32 s57, s28, 11501568
    s_mov_b32 s47, 0xffff0000
    s_waitcnt lgkmcnt(0)
    ds_read_b128 v[56:59], v90 offset:40960
    ds_read_b128 v[60:63], v90 offset:41472
    ds_read_b128 v[64:67], v90 offset:41984
    ds_read_b128 v[68:71], v90 offset:42496
    s_waitcnt lgkmcnt(3)
    v_mfma_f32_32x32x16_bf16 v[40:55], v[208:211], v[56:59], 0
    ds_read_b128 v[56:59], v90 offset:43008
    s_waitcnt lgkmcnt(3)
    v_mfma_f32_32x32x16_bf16 v[40:55], v[212:215], v[60:63], v[40:55]
    ds_read_b128 v[60:63], v90 offset:43520
    s_waitcnt lgkmcnt(3)
    v_mfma_f32_32x32x16_bf16 v[40:55], v[216:219], v[64:67], v[40:55]
    ds_read_b128 v[64:67], v90 offset:44032
    s_waitcnt lgkmcnt(3)
    v_mfma_f32_32x32x16_bf16 v[40:55], v[220:223], v[68:71], v[40:55]
    ds_read_b128 v[68:71], v90 offset:44544
    s_waitcnt lgkmcnt(3)
    v_mfma_f32_32x32x16_bf16 v[40:55], v[224:227], v[56:59], v[40:55]
    ds_read_b128 v[56:59], v90 offset:45056
    s_waitcnt lgkmcnt(3)
    v_mfma_f32_32x32x16_bf16 v[40:55], v[228:231], v[60:63], v[40:55]
    ds_read_b128 v[60:63], v90 offset:45568
    s_waitcnt lgkmcnt(3)
    v_mfma_f32_32x32x16_bf16 v[40:55], v[232:235], v[64:67], v[40:55]
    ds_read_b128 v[64:67], v90 offset:46080
    s_waitcnt lgkmcnt(3)
    v_mfma_f32_32x32x16_bf16 v[40:55], v[236:239], v[68:71], v[40:55]
    ds_read_b128 v[68:71], v90 offset:46592
    s_lshl_b32 s28, s3, 7
    s_add_u32 s28, s28, 154112
    v_lshl_add_u32 v91, v6, 4, s28
    ds_read_b128 v[208:211], v91 offset:0
    ds_read_b128 v[212:215], v91 offset:32
    ds_read_b128 v[216:219], v91 offset:64
    ds_read_b128 v[220:223], v91 offset:96
    s_waitcnt lgkmcnt(7)
    v_mfma_f32_32x32x16_bf16 v[40:55], v[240:243], v[56:59], v[40:55]
    ds_read_b128 v[56:59], v90 offset:47104
    s_waitcnt lgkmcnt(3)
    v_mfma_f32_32x32x16_bf16 v[40:55], v[244:247], v[60:63], v[40:55]
    v_lshlrev_b32 v224, 16, v72
    v_and_b32 v225, s47, v72
    v_lshlrev_b32 v226, 16, v73
    v_and_b32 v227, s47, v73
    v_lshlrev_b32 v228, 16, v74
    v_and_b32 v229, s47, v74
    v_lshlrev_b32 v230, 16, v75
    v_and_b32 v231, s47, v75
    ds_read_b128 v[60:63], v90 offset:47616
    s_waitcnt lgkmcnt(3)
    v_mfma_f32_32x32x16_bf16 v[40:55], v[248:251], v[64:67], v[40:55]
    v_lshlrev_b32 v232, 16, v76
    v_and_b32 v233, s47, v76
    v_lshlrev_b32 v234, 16, v77
    v_and_b32 v235, s47, v77
    v_lshlrev_b32 v236, 16, v78
    v_and_b32 v237, s47, v78
    v_lshlrev_b32 v238, 16, v79
    v_and_b32 v239, s47, v79
    ds_read_b128 v[64:67], v90 offset:48128
    s_waitcnt lgkmcnt(3)
    v_mfma_f32_32x32x16_bf16 v[40:55], v[252:255], v[68:71], v[40:55]
    ds_read_b128 v[68:71], v90 offset:48640
    s_waitcnt lgkmcnt(3)
    v_mfma_f32_32x32x16_bf16 v[40:55], v[96:99], v[56:59], v[40:55]
    v_fma_f32 v16, -v80, v208, v224
    v_fma_f32 v17, -v80, v209, v225
    v_fma_f32 v18, -v80, v210, v226
    v_fma_f32 v19, -v80, v211, v227
    v_fma_f32 v24, v24, v81, v16
    v_fma_f32 v25, v25, v81, v17
    ds_read_b128 v[56:59], v90 offset:49152
    s_waitcnt lgkmcnt(3)
    v_mfma_f32_32x32x16_bf16 v[40:55], v[100:103], v[60:63], v[40:55]
    v_fma_f32 v26, v26, v81, v18
    v_fma_f32 v27, v27, v81, v19
    v_mul_f32 v16, v24, v24
    v_mul_f32 v17, v25, v25
    v_mul_f32 v18, v26, v26
    v_mul_f32 v19, v27, v27
    ds_read_b128 v[60:63], v90 offset:49664
    s_waitcnt lgkmcnt(3)
    v_mfma_f32_32x32x16_bf16 v[40:55], v[104:107], v[64:67], v[40:55]
    v_fma_f32 v16, v16, v86, v84
    v_fma_f32 v17, v17, v86, v84
    v_fma_f32 v18, v18, v86, v84
    v_fma_f32 v19, v19, v86, v84
    v_mul_f32 v16, v16, v24
    v_mul_f32 v17, v17, v25
    ds_read_b128 v[64:67], v90 offset:50176
    s_waitcnt lgkmcnt(3)
    v_mfma_f32_32x32x16_bf16 v[40:55], v[108:111], v[68:71], v[40:55]
    v_mul_f32 v18, v18, v26
    v_mul_f32 v19, v19, v27
    v_exp_f32 v16, v16
    v_exp_f32 v17, v17
    v_exp_f32 v18, v18
    v_exp_f32 v19, v19
    ds_read_b128 v[68:71], v90 offset:50688
    s_waitcnt lgkmcnt(3)
    v_mfma_f32_32x32x16_bf16 v[40:55], v[112:115], v[56:59], v[40:55]
    v_add_f32 v16, 1.0, v16
    v_add_f32 v17, 1.0, v17
    v_add_f32 v18, 1.0, v18
    v_add_f32 v19, 1.0, v19
    v_rcp_f32 v16, v16
    v_rcp_f32 v17, v17
    ds_read_b128 v[56:59], v90 offset:51200
    s_waitcnt lgkmcnt(3)
    v_mfma_f32_32x32x16_bf16 v[40:55], v[116:119], v[60:63], v[40:55]
    v_rcp_f32 v18, v18
    v_rcp_f32 v19, v19
    v_mul_f32 v24, v24, v16
    v_mul_f32 v25, v25, v17
    v_mul_f32 v26, v26, v18
    v_mul_f32 v27, v27, v19
    ds_read_b128 v[60:63], v90 offset:51712
    s_waitcnt lgkmcnt(3)
    v_mfma_f32_32x32x16_bf16 v[40:55], v[120:123], v[64:67], v[40:55]
    v_cvt_pk_bf16_f32 v20, v24, v25
    v_cvt_pk_bf16_f32 v21, v26, v27
    buffer_store_dwordx2 v[20:21], v95, s[8:11], s56 offen offset:0 sc1
    v_fma_f32 v16, -v80, v212, v228
    v_fma_f32 v17, -v80, v213, v229
    v_fma_f32 v18, -v80, v214, v230
    ds_read_b128 v[64:67], v90 offset:52224
    s_waitcnt lgkmcnt(3)
    v_mfma_f32_32x32x16_bf16 v[40:55], v[124:127], v[68:71], v[40:55]
    v_fma_f32 v19, -v80, v215, v231
    v_fma_f32 v28, v28, v81, v16
    v_fma_f32 v29, v29, v81, v17
    v_fma_f32 v30, v30, v81, v18
    v_fma_f32 v31, v31, v81, v19
    v_mul_f32 v16, v28, v28
    ds_read_b128 v[68:71], v90 offset:52736
    s_waitcnt lgkmcnt(3)
    v_mfma_f32_32x32x16_bf16 v[40:55], v[128:131], v[56:59], v[40:55]
    v_mul_f32 v17, v29, v29
    v_mul_f32 v18, v30, v30
    v_mul_f32 v19, v31, v31
    v_fma_f32 v16, v16, v86, v84
    v_fma_f32 v17, v17, v86, v84
    v_fma_f32 v18, v18, v86, v84
    ds_read_b128 v[56:59], v90 offset:53248
    s_waitcnt lgkmcnt(3)
    v_mfma_f32_32x32x16_bf16 v[40:55], v[132:135], v[60:63], v[40:55]
    v_fma_f32 v19, v19, v86, v84
    v_mul_f32 v16, v16, v28
    v_mul_f32 v17, v17, v29
    v_mul_f32 v18, v18, v30
    v_mul_f32 v19, v19, v31
    v_exp_f32 v16, v16
    ds_read_b128 v[60:63], v90 offset:53760
    s_waitcnt lgkmcnt(3)
    v_mfma_f32_32x32x16_bf16 v[40:55], v[136:139], v[64:67], v[40:55]
    v_exp_f32 v17, v17
    v_exp_f32 v18, v18
    v_exp_f32 v19, v19
    v_add_f32 v16, 1.0, v16
    v_add_f32 v17, 1.0, v17
    v_add_f32 v18, 1.0, v18
    ds_read_b128 v[64:67], v90 offset:54272
    s_waitcnt lgkmcnt(3)
    v_mfma_f32_32x32x16_bf16 v[40:55], v[140:143], v[68:71], v[40:55]
    v_add_f32 v19, 1.0, v19
    v_rcp_f32 v16, v16
    v_rcp_f32 v17, v17
    v_rcp_f32 v18, v18
    v_rcp_f32 v19, v19
    v_mul_f32 v28, v28, v16
    ds_read_b128 v[68:71], v90 offset:54784
    s_waitcnt lgkmcnt(3)
    v_mfma_f32_32x32x16_bf16 v[40:55], v[144:147], v[56:59], v[40:55]
    v_mul_f32 v29, v29, v17
    v_mul_f32 v30, v30, v18
    v_mul_f32 v31, v31, v19
    v_cvt_pk_bf16_f32 v20, v28, v29
    v_cvt_pk_bf16_f32 v21, v30, v31
    buffer_store_dwordx2 v[20:21], v95, s[8:11], s56 offen offset:256 sc1
    ds_read_b128 v[56:59], v90 offset:55296
    s_waitcnt lgkmcnt(3)
    v_mfma_f32_32x32x16_bf16 v[40:55], v[148:151], v[60:63], v[40:55]
    v_fma_f32 v16, -v80, v216, v232
    v_fma_f32 v17, -v80, v217, v233
    v_fma_f32 v18, -v80, v218, v234
    v_fma_f32 v19, -v80, v219, v235
    v_fma_f32 v32, v32, v81, v16
    v_fma_f32 v33, v33, v81, v17
    ds_read_b128 v[60:63], v90 offset:55808
    s_waitcnt lgkmcnt(3)
    v_mfma_f32_32x32x16_bf16 v[40:55], v[152:155], v[64:67], v[40:55]
    v_fma_f32 v34, v34, v81, v18
    v_fma_f32 v35, v35, v81, v19
    v_mul_f32 v16, v32, v32
    v_mul_f32 v17, v33, v33
    v_mul_f32 v18, v34, v34
    v_mul_f32 v19, v35, v35
    ds_read_b128 v[64:67], v90 offset:56320
    s_waitcnt lgkmcnt(3)
    v_mfma_f32_32x32x16_bf16 v[40:55], v[156:159], v[68:71], v[40:55]
    v_fma_f32 v16, v16, v86, v84
    v_fma_f32 v17, v17, v86, v84
    v_fma_f32 v18, v18, v86, v84
    v_fma_f32 v19, v19, v86, v84
    v_mul_f32 v16, v16, v32
    v_mul_f32 v17, v17, v33
    ds_read_b128 v[68:71], v90 offset:56832
    s_waitcnt lgkmcnt(3)
    v_mfma_f32_32x32x16_bf16 v[40:55], v[160:163], v[56:59], v[40:55]
    v_mul_f32 v18, v18, v34
    v_mul_f32 v19, v19, v35
    v_exp_f32 v16, v16
    v_exp_f32 v17, v17
    v_exp_f32 v18, v18
    v_exp_f32 v19, v19
    ds_read_b128 v[56:59], v90 offset:57344
    s_waitcnt lgkmcnt(3)
    v_mfma_f32_32x32x16_bf16 v[40:55], v[164:167], v[60:63], v[40:55]
    v_add_f32 v16, 1.0, v16
    v_add_f32 v17, 1.0, v17
    v_add_f32 v18, 1.0, v18
    v_add_f32 v19, 1.0, v19
    v_rcp_f32 v16, v16
    v_rcp_f32 v17, v17
    ds_read_b128 v[60:63], v90 offset:57856
    s_waitcnt lgkmcnt(3)
    v_mfma_f32_32x32x16_bf16 v[40:55], v[168:171], v[64:67], v[40:55]
    v_rcp_f32 v18, v18
    v_rcp_f32 v19, v19
    v_mul_f32 v32, v32, v16
    v_mul_f32 v33, v33, v17
    v_mul_f32 v34, v34, v18
    v_mul_f32 v35, v35, v19
    ds_read_b128 v[64:67], v90 offset:58368
    s_waitcnt lgkmcnt(3)
    v_mfma_f32_32x32x16_bf16 v[40:55], v[172:175], v[68:71], v[40:55]
    v_cvt_pk_bf16_f32 v20, v32, v33
    v_cvt_pk_bf16_f32 v21, v34, v35
    buffer_store_dwordx2 v[20:21], v95, s[8:11], s56 offen offset:512 sc1
    v_fma_f32 v16, -v80, v220, v236
    v_fma_f32 v17, -v80, v221, v237
    v_fma_f32 v18, -v80, v222, v238
    ds_read_b128 v[68:71], v90 offset:58880
    s_waitcnt lgkmcnt(3)
    v_mfma_f32_32x32x16_bf16 v[40:55], v[176:179], v[56:59], v[40:55]
    v_fma_f32 v19, -v80, v223, v239
    v_fma_f32 v36, v36, v81, v16
    v_fma_f32 v37, v37, v81, v17
    v_fma_f32 v38, v38, v81, v18
    v_fma_f32 v39, v39, v81, v19
    v_mul_f32 v16, v36, v36
    ds_read_b128 v[56:59], v90 offset:59392
    s_waitcnt lgkmcnt(3)
    v_mfma_f32_32x32x16_bf16 v[40:55], v[180:183], v[60:63], v[40:55]
    v_mul_f32 v17, v37, v37
    v_mul_f32 v18, v38, v38
    v_mul_f32 v19, v39, v39
    v_fma_f32 v16, v16, v86, v84
    v_fma_f32 v17, v17, v86, v84
    v_fma_f32 v18, v18, v86, v84
    ds_read_b128 v[60:63], v90 offset:59904
    s_waitcnt lgkmcnt(3)
    v_mfma_f32_32x32x16_bf16 v[40:55], v[184:187], v[64:67], v[40:55]
    v_fma_f32 v19, v19, v86, v84
    v_mul_f32 v16, v16, v36
    v_mul_f32 v17, v17, v37
    v_mul_f32 v18, v18, v38
    v_mul_f32 v19, v19, v39
    v_exp_f32 v16, v16
    ds_read_b128 v[64:67], v90 offset:60416
    s_waitcnt lgkmcnt(3)
    v_mfma_f32_32x32x16_bf16 v[40:55], v[188:191], v[68:71], v[40:55]
    v_exp_f32 v17, v17
    v_exp_f32 v18, v18
    v_exp_f32 v19, v19
    v_add_f32 v16, 1.0, v16
    v_add_f32 v17, 1.0, v17
    v_add_f32 v18, 1.0, v18
    ds_read_b128 v[68:71], v90 offset:60928
    s_waitcnt lgkmcnt(3)
    v_mfma_f32_32x32x16_bf16 v[40:55], v[192:195], v[56:59], v[40:55]
    v_add_f32 v19, 1.0, v19
    v_rcp_f32 v16, v16
    v_rcp_f32 v17, v17
    v_rcp_f32 v18, v18
    v_rcp_f32 v19, v19
    v_mul_f32 v36, v36, v16
    s_waitcnt lgkmcnt(2)
    v_mfma_f32_32x32x16_bf16 v[40:55], v[196:199], v[60:63], v[40:55]
    v_mul_f32 v37, v37, v17
    v_mul_f32 v38, v38, v18
    v_mul_f32 v39, v39, v19
    v_cvt_pk_bf16_f32 v20, v36, v37
    v_cvt_pk_bf16_f32 v21, v38, v39
    buffer_store_dwordx2 v[20:21], v95, s[8:11], s56 offen offset:768 sc1
    s_waitcnt lgkmcnt(1)
    v_mfma_f32_32x32x16_bf16 v[40:55], v[200:203], v[64:67], v[40:55]
    s_waitcnt lgkmcnt(0)
    v_mfma_f32_32x32x16_bf16 v[40:55], v[204:207], v[68:71], v[40:55]
    s_barrier
    s_add_u32 s52, s3, 8
    v_pk_fma_f32 v[16:17], v[82:83], v[208:209], v[224:225] op_sel_hi:[0,1,1] neg_lo:[1,0,0] neg_hi:[1,0,0]
    v_pk_fma_f32 v[18:19], v[82:83], v[210:211], v[226:227] op_sel_hi:[0,1,1] neg_lo:[1,0,0] neg_hi:[1,0,0]
    s_nop 7
    v_pk_fma_f32 v[40:41], v[40:41], v[82:83], v[16:17] op_sel:[0,1,0] op_sel_hi:[1,1,1]
    v_pk_fma_f32 v[42:43], v[42:43], v[82:83], v[18:19] op_sel:[0,1,0] op_sel_hi:[1,1,1]
    v_pk_mul_f32 v[16:17], v[40:41], v[40:41]
    v_pk_mul_f32 v[18:19], v[42:43], v[42:43]
    v_pk_fma_f32 v[16:17], v[16:17], v[86:87], v[84:85]
    v_pk_fma_f32 v[18:19], v[18:19], v[86:87], v[84:85]
    v_pk_mul_f32 v[16:17], v[16:17], v[40:41]
    v_pk_mul_f32 v[18:19], v[18:19], v[42:43]
    v_exp_f32 v16, v16
    v_exp_f32 v17, v17
    v_exp_f32 v18, v18
    v_exp_f32 v19, v19
    v_pk_add_f32 v[16:17], v[16:17], v[92:93]
    v_pk_add_f32 v[18:19], v[18:19], v[92:93]
    v_rcp_f32 v16, v16
    v_rcp_f32 v17, v17
    v_rcp_f32 v18, v18
    v_rcp_f32 v19, v19
    v_pk_mul_f32 v[40:41], v[40:41], v[16:17]
    v_pk_mul_f32 v[42:43], v[42:43], v[18:19]
    v_cvt_pk_bf16_f32 v20, v40, v41
    v_cvt_pk_bf16_f32 v21, v42, v43
    buffer_store_dwordx2 v[20:21], v95, s[8:11], s57 offen offset:0 sc1
    s_lshr_b32 s53, s52, 1
    s_and_b32 s54, s52, 1
    s_mul_i32 s54, s54, 27
    s_add_u32 s54, s54, s53
    s_mul_i32 s55, s7, 270
    s_add_u32 s54, s54, s55
    s_lshl_b32 s54, s54, 10
    s_add_u32 s54, s54, 30490624
    s_mul_i32 s55, s52, 5120
    s_mov_b32 m0, s55
    s_nop 0
    buffer_load_dwordx4 v4, s[8:11], s54 offen sc1 lds
    s_add_u32 s54, s54, 55296
    s_add_u32 s55, s55, 1024
    v_pk_fma_f32 v[16:17], v[82:83], v[212:213], v[228:229] op_sel_hi:[0,1,1] neg_lo:[1,0,0] neg_hi:[1,0,0]
    v_pk_fma_f32 v[18:19], v[82:83], v[214:215], v[230:231] op_sel_hi:[0,1,1] neg_lo:[1,0,0] neg_hi:[1,0,0]
    v_pk_fma_f32 v[44:45], v[44:45], v[82:83], v[16:17] op_sel:[0,1,0] op_sel_hi:[1,1,1]
    v_pk_fma_f32 v[46:47], v[46:47], v[82:83], v[18:19] op_sel:[0,1,0] op_sel_hi:[1,1,1]
    v_pk_mul_f32 v[16:17], v[44:45], v[44:45]
    v_pk_mul_f32 v[18:19], v[46:47], v[46:47]
    v_pk_fma_f32 v[16:17], v[16:17], v[86:87], v[84:85]
    v_pk_fma_f32 v[18:19], v[18:19], v[86:87], v[84:85]
    v_pk_mul_f32 v[16:17], v[16:17], v[44:45]
    v_pk_mul_f32 v[18:19], v[18:19], v[46:47]
    v_exp_f32 v16, v16
    v_exp_f32 v17, v17
    v_exp_f32 v18, v18
    v_exp_f32 v19, v19
    v_pk_add_f32 v[16:17], v[16:17], v[92:93]
    v_pk_add_f32 v[18:19], v[18:19], v[92:93]
    v_rcp_f32 v16, v16
    v_rcp_f32 v17, v17
    v_rcp_f32 v18, v18
    v_rcp_f32 v19, v19
    v_pk_mul_f32 v[44:45], v[44:45], v[16:17]
    v_pk_mul_f32 v[46:47], v[46:47], v[18:19]
    v_cvt_pk_bf16_f32 v20, v44, v45
    v_cvt_pk_bf16_f32 v21, v46, v47
    buffer_store_dwordx2 v[20:21], v95, s[8:11], s57 offen offset:256 sc1
    s_mov_b32 m0, s55
    s_nop 0
    buffer_load_dwordx4 v4, s[8:11], s54 offen sc1 lds
    s_add_u32 s54, s54, 55296
    s_add_u32 s55, s55, 1024
    v_pk_fma_f32 v[16:17], v[82:83], v[216:217], v[232:233] op_sel_hi:[0,1,1] neg_lo:[1,0,0] neg_hi:[1,0,0]
    v_pk_fma_f32 v[18:19], v[82:83], v[218:219], v[234:235] op_sel_hi:[0,1,1] neg_lo:[1,0,0] neg_hi:[1,0,0]
    v_pk_fma_f32 v[48:49], v[48:49], v[82:83], v[16:17] op_sel:[0,1,0] op_sel_hi:[1,1,1]
    v_pk_fma_f32 v[50:51], v[50:51], v[82:83], v[18:19] op_sel:[0,1,0] op_sel_hi:[1,1,1]
    v_pk_mul_f32 v[16:17], v[48:49], v[48:49]
    v_pk_mul_f32 v[18:19], v[50:51], v[50:51]
    v_pk_fma_f32 v[16:17], v[16:17], v[86:87], v[84:85]
    v_pk_fma_f32 v[18:19], v[18:19], v[86:87], v[84:85]
    v_pk_mul_f32 v[16:17], v[16:17], v[48:49]
    v_pk_mul_f32 v[18:19], v[18:19], v[50:51]
    v_exp_f32 v16, v16
    v_exp_f32 v17, v17
    v_exp_f32 v18, v18
    v_exp_f32 v19, v19
    v_pk_add_f32 v[16:17], v[16:17], v[92:93]
    v_pk_add_f32 v[18:19], v[18:19], v[92:93]
    v_rcp_f32 v16, v16
    v_rcp_f32 v17, v17
    v_rcp_f32 v18, v18
    v_rcp_f32 v19, v19
    v_pk_mul_f32 v[48:49], v[48:49], v[16:17]
    v_pk_mul_f32 v[50:51], v[50:51], v[18:19]
    v_cvt_pk_bf16_f32 v20, v48, v49
    v_cvt_pk_bf16_f32 v21, v50, v51
    buffer_store_dwordx2 v[20:21], v95, s[8:11], s57 offen offset:512 sc1
    s_mov_b32 m0, s55
    s_nop 0
    buffer_load_dwordx4 v4, s[8:11], s54 offen sc1 lds
    s_add_u32 s54, s54, 55296
    s_add_u32 s55, s55, 1024
    v_pk_fma_f32 v[16:17], v[82:83], v[220:221], v[236:237] op_sel_hi:[0,1,1] neg_lo:[1,0,0] neg_hi:[1,0,0]
    v_pk_fma_f32 v[18:19], v[82:83], v[222:223], v[238:239] op_sel_hi:[0,1,1] neg_lo:[1,0,0] neg_hi:[1,0,0]
    v_pk_fma_f32 v[52:53], v[52:53], v[82:83], v[16:17] op_sel:[0,1,0] op_sel_hi:[1,1,1]
    v_pk_fma_f32 v[54:55], v[54:55], v[82:83], v[18:19] op_sel:[0,1,0] op_sel_hi:[1,1,1]
    v_pk_mul_f32 v[16:17], v[52:53], v[52:53]
    v_pk_mul_f32 v[18:19], v[54:55], v[54:55]
    v_pk_fma_f32 v[16:17], v[16:17], v[86:87], v[84:85]
    v_pk_fma_f32 v[18:19], v[18:19], v[86:87], v[84:85]
    v_pk_mul_f32 v[16:17], v[16:17], v[52:53]
    v_pk_mul_f32 v[18:19], v[18:19], v[54:55]
    v_exp_f32 v16, v16
    v_exp_f32 v17, v17
    v_exp_f32 v18, v18
    v_exp_f32 v19, v19
    v_pk_add_f32 v[16:17], v[16:17], v[92:93]
    v_pk_add_f32 v[18:19], v[18:19], v[92:93]
    v_rcp_f32 v16, v16
    v_rcp_f32 v17, v17
    v_rcp_f32 v18, v18
    v_rcp_f32 v19, v19
    v_pk_mul_f32 v[52:53], v[52:53], v[16:17]
    v_pk_mul_f32 v[54:55], v[54:55], v[18:19]
    v_cvt_pk_bf16_f32 v20, v52, v53
    v_cvt_pk_bf16_f32 v21, v54, v55
    buffer_store_dwordx2 v[20:21], v95, s[8:11], s57 offen offset:768 sc1
    s_mov_b32 m0, s55
    s_nop 0
    buffer_load_dwordx4 v4, s[8:11], s54 offen sc1 lds
    s_add_u32 s54, s54, 55296
    s_add_u32 s55, s55, 1024
    s_mov_b32 m0, s55
    s_nop 0
    buffer_load_dwordx4 v4, s[8:11], s54 offen sc1 lds
    s_add_u32 s54, s54, 55296
    s_add_u32 s55, s55, 1024
interleave_layers__grouped_kv_mqa__mixer_channel_mlp__prompt_kernel_fin84:
    s_waitcnt vmcnt(0)
    s_barrier
    s_cmp_lg_u32 s3, 0
    s_cbranch_scc1 interleave_layers__grouped_kv_mqa__mixer_channel_mlp__prompt_kernel_pub90
    s_add_u32 s28, s13, 4
    v_mov_b32 v22, s28
    s_lshl_b32 s29, s6, 8
    s_lshl_b32 s30, s7, 2
    s_add_u32 s29, s29, s30
    v_mov_b32 v21, s29
    s_mov_b64 exec, 1
    buffer_store_dword v22, v21, s[8:11], 0 offen offset:0 sc1
    s_mov_b64 exec, -1
interleave_layers__grouped_kv_mqa__mixer_channel_mlp__prompt_kernel_pub90:
    s_mov_b32 s20, s82
    s_mov_b32 s21, s83
    s_and_b32 s21, s21, 0xffff
    s_mov_b32 s22, 1280
    s_mov_b32 s23, 0x20000
    s_mov_b32 s24, s84
    s_mov_b32 s25, s85
    s_and_b32 s25, s25, 0xffff
    s_mov_b32 s26, 2621440
    s_mov_b32 s27, 0x20000
    s_mul_i32 s28, s7, 160
    s_mul_i32 s29, s5, 96
    s_add_u32 s28, s28, s29
    v_lshl_add_u32 v236, v3, 3, s28
    buffer_load_dwordx2 v[240:241], v236, s[20:23], 0 offen offset:0
    buffer_load_dwordx2 v[242:243], v236, s[20:23], 0 offen offset:32
    buffer_load_dwordx2 v[244:245], v236, s[20:23], 0 offen offset:64
    s_movk_i32 s29, 1280
    v_mul_lo_u32 v246, v14, s29
    v_add_u32 v246, v246, v236
    s_cmp_lg_u32 s3, 7
    s_cbranch_scc1 interleave_layers__grouped_kv_mqa__mixer_channel_mlp__prompt_kernel_w91
    s_add_u32 s28, s13, 4
    v_and_b32 v21, 7, v1
    v_lshlrev_b32 v21, 2, v21
    s_lshl_b32 s29, s6, 8
    v_add_u32 v21, s29, v21
    v_mov_b32 v22, s28
    s_mov_b32 s30, 0
interleave_layers__grouped_kv_mqa__mixer_channel_mlp__prompt_kernel_poll92:
    buffer_load_dword v16, v21, s[8:11], 0 offen offset:0 sc1
    s_waitcnt vmcnt(0)
    v_sub_u32 v16, v16, v22
    v_cmp_le_u32 vcc, 32, v16
    s_cbranch_vccz interleave_layers__grouped_kv_mqa__mixer_channel_mlp__prompt_kernel_pd93
    s_sleep 1
    s_add_u32 s30, s30, 1
    s_cmp_lt_u32 s30, 0x40000
    s_cbranch_scc1 interleave_layers__grouped_kv_mqa__mixer_channel_mlp__prompt_kernel_poll92
interleave_layers__grouped_kv_mqa__mixer_channel_mlp__prompt_kernel_pd93:
interleave_layers__grouped_kv_mqa__mixer_channel_mlp__prompt_kernel_w91:
    s_barrier
    s_lshl_b32 s28, s6, 2
    s_add_u32 s28, s28, s4
    s_mul_i32 s28, s28, 54
    s_mul_i32 s29, s5, 27
    s_add_u32 s28, s28, s29
    s_lshl_b32 s28, s28, 10
    s_mul_i32 s29, s12, 7077888
    s_add_u32 s28, s28, s29
    s_add_u32 s28, s28, 11501568
    buffer_load_dwordx4 v[24:27], v4, s[8:11], s28 offen offset:0 sc1
    buffer_load_dwordx4 v[28:31], v4, s[8:11], s28 offen offset:1024 sc1
    buffer_load_dwordx4 v[32:35], v4, s[8:11], s28 offen offset:2048 sc1
    buffer_load_dwordx4 v[36:39], v4, s[8:11], s28 offen offset:3072 sc1
    s_add_u32 s28, s28, 4096
    buffer_load_dwordx4 v[40:43], v4, s[8:11], s28 offen offset:0 sc1
    buffer_load_dwordx4 v[44:47], v4, s[8:11], s28 offen offset:1024 sc1
    buffer_load_dwordx4 v[48:51], v4, s[8:11], s28 offen offset:2048 sc1
    buffer_load_dwordx4 v[52:55], v4, s[8:11], s28 offen offset:3072 sc1
    s_add_u32 s28, s28, 4096
    buffer_load_dwordx4 v[56:59], v4, s[8:11], s28 offen offset:0 sc1
    buffer_load_dwordx4 v[60:63], v4, s[8:11], s28 offen offset:1024 sc1
    buffer_load_dwordx4 v[64:67], v4, s[8:11], s28 offen offset:2048 sc1
    buffer_load_dwordx4 v[68:71], v4, s[8:11], s28 offen offset:3072 sc1
    s_add_u32 s28, s28, 4096
    buffer_load_dwordx4 v[72:75], v4, s[8:11], s28 offen offset:0 sc1
    buffer_load_dwordx4 v[76:79], v4, s[8:11], s28 offen offset:1024 sc1
    buffer_load_dwordx4 v[80:83], v4, s[8:11], s28 offen offset:2048 sc1
    buffer_load_dwordx4 v[84:87], v4, s[8:11], s28 offen offset:3072 sc1
    s_add_u32 s28, s28, 4096
    buffer_load_dwordx4 v[88:91], v4, s[8:11], s28 offen offset:0 sc1
    buffer_load_dwordx4 v[92:95], v4, s[8:11], s28 offen offset:1024 sc1
    buffer_load_dwordx4 v[96:99], v4, s[8:11], s28 offen offset:2048 sc1
    buffer_load_dwordx4 v[100:103], v4, s[8:11], s28 offen offset:3072 sc1
    s_add_u32 s28, s28, 4096
    buffer_load_dwordx4 v[104:107], v4, s[8:11], s28 offen offset:0 sc1
    buffer_load_dwordx4 v[108:111], v4, s[8:11], s28 offen offset:1024 sc1
    buffer_load_dwordx4 v[112:115], v4, s[8:11], s28 offen offset:2048 sc1
    buffer_load_dwordx4 v[116:119], v4, s[8:11], s28 offen offset:3072 sc1
    s_add_u32 s28, s28, 4096
    buffer_load_dwordx4 v[120:123], v4, s[8:11], s28 offen offset:0 sc1
    buffer_load_dwordx4 v[124:127], v4, s[8:11], s28 offen offset:1024 sc1
    buffer_load_dwordx4 v[128:131], v4, s[8:11], s28 offen offset:2048 sc1
    s_mul_i32 s28, s5, 5120
    v_add_u32 v236, s28, v4
    v_add_u32 v237, 61440, v236
    v_add_u32 v238, 122880, v236
    ds_read_b128 v[132:135], v236 offset:0
    ds_read_b128 v[136:139], v236 offset:1024
    ds_read_b128 v[140:143], v236 offset:2048
    ds_read_b128 v[144:147], v236 offset:3072
    ds_read_b128 v[148:151], v236 offset:4096
    ds_read_b128 v[152:155], v236 offset:10240
    ds_read_b128 v[156:159], v236 offset:11264
    ds_read_b128 v[160:163], v236 offset:12288
    ds_read_b128 v[164:167], v236 offset:13312
    ds_read_b128 v[168:171], v236 offset:14336
    ds_read_b128 v[172:175], v236 offset:20480
    s_waitcnt lgkmcnt(10) vmcnt(26)
    v_mfma_f32_16x16x32_bf16 v[192:195], v[132:135], v[24:27], 0
    ds_read_b128 v[132:135], v236 offset:21504
    s_waitcnt lgkmcnt(10)
    v_mfma_f32_16x16x32_bf16 v[196:199], v[136:139], v[24:27], 0
    ds_read_b128 v[136:139], v236 offset:22528
    s_waitcnt lgkmcnt(10)
    v_mfma_f32_16x16x32_bf16 v[200:203], v[140:143], v[24:27], 0
    ds_read_b128 v[140:143], v236 offset:23552
    s_waitcnt lgkmcnt(10)
    v_mfma_f32_16x16x32_bf16 v[204:207], v[144:147], v[24:27], 0
    ds_read_b128 v[144:147], v236 offset:24576
    s_waitcnt lgkmcnt(10)
    v_mfma_f32_16x16x32_bf16 v[208:211], v[148:151], v[24:27], 0
    ds_read_b128 v[148:151], v236 offset:30720
    s_waitcnt lgkmcnt(10) vmcnt(25)
    v_mfma_f32_16x16x32_bf16 v[192:195], v[152:155], v[28:31], v[192:195]
    ds_read_b128 v[152:155], v236 offset:31744
    s_waitcnt lgkmcnt(10)
    v_mfma_f32_16x16x32_bf16 v[196:199], v[156:159], v[28:31], v[196:199]
    ds_read_b128 v[156:159], v236 offset:32768
    s_waitcnt lgkmcnt(10)
    v_mfma_f32_16x16x32_bf16 v[200:203], v[160:163], v[28:31], v[200:203]
    ds_read_b128 v[160:163], v236 offset:33792
    s_waitcnt lgkmcnt(10)
    v_mfma_f32_16x16x32_bf16 v[204:207], v[164:167], v[28:31], v[204:207]
    ds_read_b128 v[164:167], v236 offset:34816
    s_waitcnt lgkmcnt(10)
    v_mfma_f32_16x16x32_bf16 v[208:211], v[168:171], v[28:31], v[208:211]
    ds_read_b128 v[168:171], v236 offset:40960
    s_waitcnt lgkmcnt(10) vmcnt(24)
    v_mfma_f32_16x16x32_bf16 v[192:195], v[172:175], v[32:35], v[192:195]
    ds_read_b128 v[172:175], v236 offset:41984
    s_waitcnt lgkmcnt(10)
    v_mfma_f32_16x16x32_bf16 v[196:199], v[132:135], v[32:35], v[196:199]
    ds_read_b128 v[132:135], v236 offset:43008
    s_waitcnt lgkmcnt(10)
    v_mfma_f32_16x16x32_bf16 v[200:203], v[136:139], v[32:35], v[200:203]
    ds_read_b128 v[136:139], v236 offset:44032
    s_waitcnt lgkmcnt(10)
    v_mfma_f32_16x16x32_bf16 v[204:207], v[140:143], v[32:35], v[204:207]
    ds_read_b128 v[140:143], v236 offset:45056
    s_waitcnt lgkmcnt(10)
    v_mfma_f32_16x16x32_bf16 v[208:211], v[144:147], v[32:35], v[208:211]
    ds_read_b128 v[144:147], v236 offset:51200
    s_waitcnt lgkmcnt(10) vmcnt(23)
    v_mfma_f32_16x16x32_bf16 v[192:195], v[148:151], v[36:39], v[192:195]
    ds_read_b128 v[148:151], v236 offset:52224
    s_waitcnt lgkmcnt(10)
    v_mfma_f32_16x16x32_bf16 v[196:199], v[152:155], v[36:39], v[196:199]
    ds_read_b128 v[152:155], v236 offset:53248
    s_waitcnt lgkmcnt(10)
    v_mfma_f32_16x16x32_bf16 v[200:203], v[156:159], v[36:39], v[200:203]
    ds_read_b128 v[156:159], v236 offset:54272
    s_waitcnt lgkmcnt(10)
    v_mfma_f32_16x16x32_bf16 v[204:207], v[160:163], v[36:39], v[204:207]
    ds_read_b128 v[160:163], v236 offset:55296
    s_waitcnt lgkmcnt(10)
    v_mfma_f32_16x16x32_bf16 v[208:211], v[164:167], v[36:39], v[208:211]
    ds_read_b128 v[164:167], v237 offset:0
    s_waitcnt lgkmcnt(10) vmcnt(22)
    v_mfma_f32_16x16x32_bf16 v[192:195], v[168:171], v[40:43], v[192:195]
    ds_read_b128 v[168:171], v237 offset:1024
    s_waitcnt lgkmcnt(10)
    v_mfma_f32_16x16x32_bf16 v[196:199], v[172:175], v[40:43], v[196:199]
    ds_read_b128 v[172:175], v237 offset:2048
    s_waitcnt lgkmcnt(10)
    v_mfma_f32_16x16x32_bf16 v[200:203], v[132:135], v[40:43], v[200:203]
    ds_read_b128 v[132:135], v237 offset:3072
    s_waitcnt lgkmcnt(10)
    v_mfma_f32_16x16x32_bf16 v[204:207], v[136:139], v[40:43], v[204:207]
    ds_read_b128 v[136:139], v237 offset:4096
    s_waitcnt lgkmcnt(10)
    v_mfma_f32_16x16x32_bf16 v[208:211], v[140:143], v[40:43], v[208:211]
    s_barrier
    s_lshr_b32 s28, s3, 1
    s_and_b32 s29, s3, 1
    s_add_u32 s30, s28, 15
    s_mul_i32 s32, s29, 27
    s_add_u32 s32, s32, s30
    s_mul_i32 s33, s7, 270
    s_add_u32 s32, s32, s33
    s_lshl_b32 s32, s32, 10
    s_add_u32 s32, s32, 30490624
    s_add_u32 s30, s28, 0
    s_mul_i32 s33, s30, 10240
    s_mul_i32 s29, s29, 5120
    s_add_u32 s33, s33, s29
    s_mov_b32 m0, s33
    s_nop 0
    buffer_load_dwordx4 v4, s[8:11], s32 offen sc1 lds
    s_add_u32 s32, s32, 55296
    s_add_u32 s33, s33, 1024
    s_mov_b32 m0, s33
    s_nop 0
    buffer_load_dwordx4 v4, s[8:11], s32 offen sc1 lds
    s_add_u32 s32, s32, 55296
    s_add_u32 s33, s33, 1024
    s_mov_b32 m0, s33
    s_nop 0
    buffer_load_dwordx4 v4, s[8:11], s32 offen sc1 lds
    s_add_u32 s32, s32, 55296
    s_add_u32 s33, s33, 1024
    s_mov_b32 m0, s33
    s_nop 0
    buffer_load_dwordx4 v4, s[8:11], s32 offen sc1 lds
    s_add_u32 s32, s32, 55296
    s_add_u32 s33, s33, 1024
    s_mov_b32 m0, s33
    s_nop 0
    buffer_load_dwordx4 v4, s[8:11], s32 offen sc1 lds
    ds_read_b128 v[140:143], v237 offset:10240
    s_waitcnt lgkmcnt(10) vmcnt(26)
    v_mfma_f32_16x16x32_bf16 v[192:195], v[144:147], v[44:47], v[192:195]
    ds_read_b128 v[144:147], v237 offset:11264
    s_waitcnt lgkmcnt(10)
    v_mfma_f32_16x16x32_bf16 v[196:199], v[148:151], v[44:47], v[196:199]
    ds_read_b128 v[148:151], v237 offset:12288
    s_waitcnt lgkmcnt(10)
    v_mfma_f32_16x16x32_bf16 v[200:203], v[152:155], v[44:47], v[200:203]
    ds_read_b128 v[152:155], v237 offset:13312
    s_waitcnt lgkmcnt(10)
    v_mfma_f32_16x16x32_bf16 v[204:207], v[156:159], v[44:47], v[204:207]
    ds_read_b128 v[156:159], v237 offset:14336
    s_waitcnt lgkmcnt(10)
    v_mfma_f32_16x16x32_bf16 v[208:211], v[160:163], v[44:47], v[208:211]
    ds_read_b128 v[160:163], v237 offset:20480
    s_waitcnt lgkmcnt(10) vmcnt(25)
    v_mfma_f32_16x16x32_bf16 v[192:195], v[164:167], v[48:51], v[192:195]
    ds_read_b128 v[164:167], v237 offset:21504
    s_waitcnt lgkmcnt(10)
    v_mfma_f32_16x16x32_bf16 v[196:199], v[168:171], v[48:51], v[196:199]
    ds_read_b128 v[168:171], v237 offset:22528
    s_waitcnt lgkmcnt(10)
    v_mfma_f32_16x16x32_bf16 v[200:203], v[172:175], v[48:51], v[200:203]
    ds_read_b128 v[172:175], v237 offset:23552
    s_waitcnt lgkmcnt(10)
    v_mfma_f32_16x16x32_bf16 v[204:207], v[132:135], v[48:51], v[204:207]
    ds_read_b128 v[132:135], v237 offset:24576
    s_waitcnt lgkmcnt(10)
    v_mfma_f32_16x16x32_bf16 v[208:211], v[136:139], v[48:51], v[208:211]
    ds_read_b128 v[136:139], v237 offset:30720
    s_waitcnt lgkmcnt(10) vmcnt(24)
    v_mfma_f32_16x16x32_bf16 v[192:195], v[140:143], v[52:55], v[192:195]
    ds_read_b128 v[140:143], v237 offset:31744
    s_waitcnt lgkmcnt(10)
    v_mfma_f32_16x16x32_bf16 v[196:199], v[144:147], v[52:55], v[196:199]
    ds_read_b128 v[144:147], v237 offset:32768
    s_waitcnt lgkmcnt(10)
    v_mfma_f32_16x16x32_bf16 v[200:203], v[148:151], v[52:55], v[200:203]
    ds_read_b128 v[148:151], v237 offset:33792
    s_waitcnt lgkmcnt(10)
    v_mfma_f32_16x16x32_bf16 v[204:207], v[152:155], v[52:55], v[204:207]
    ds_read_b128 v[152:155], v237 offset:34816
    s_waitcnt lgkmcnt(10)
    v_mfma_f32_16x16x32_bf16 v[208:211], v[156:159], v[52:55], v[208:211]
    ds_read_b128 v[156:159], v237 offset:40960
    s_waitcnt lgkmcnt(10) vmcnt(23)
    v_mfma_f32_16x16x32_bf16 v[192:195], v[160:163], v[56:59], v[192:195]
    ds_read_b128 v[160:163], v237 offset:41984
    s_waitcnt lgkmcnt(10)
    v_mfma_f32_16x16x32_bf16 v[196:199], v[164:167], v[56:59], v[196:199]
    ds_read_b128 v[164:167], v237 offset:43008
    s_waitcnt lgkmcnt(10)
    v_mfma_f32_16x16x32_bf16 v[200:203], v[168:171], v[56:59], v[200:203]
    ds_read_b128 v[168:171], v237 offset:44032
    s_waitcnt lgkmcnt(10)
    v_mfma_f32_16x16x32_bf16 v[204:207], v[172:175], v[56:59], v[204:207]
    ds_read_b128 v[172:175], v237 offset:45056
    s_waitcnt lgkmcnt(10)
    v_mfma_f32_16x16x32_bf16 v[208:211], v[132:135], v[56:59], v[208:211]
    s_barrier
    s_lshr_b32 s28, s3, 1
    s_and_b32 s29, s3, 1
    s_add_u32 s30, s28, 19
    s_mul_i32 s32, s29, 27
    s_add_u32 s32, s32, s30
    s_mul_i32 s33, s7, 270
    s_add_u32 s32, s32, s33
    s_lshl_b32 s32, s32, 10
    s_add_u32 s32, s32, 30490624
    s_add_u32 s30, s28, 4
    s_mul_i32 s33, s30, 10240
    s_mul_i32 s29, s29, 5120
    s_add_u32 s33, s33, s29
    s_mov_b32 m0, s33
    s_nop 0
    buffer_load_dwordx4 v4, s[8:11], s32 offen sc1 lds
    s_add_u32 s32, s32, 55296
    s_add_u32 s33, s33, 1024
    s_mov_b32 m0, s33
    s_nop 0
    buffer_load_dwordx4 v4, s[8:11], s32 offen sc1 lds
    s_add_u32 s32, s32, 55296
    s_add_u32 s33, s33, 1024
    s_mov_b32 m0, s33
    s_nop 0
    buffer_load_dwordx4 v4, s[8:11], s32 offen sc1 lds
    s_add_u32 s32, s32, 55296
    s_add_u32 s33, s33, 1024
    s_mov_b32 m0, s33
    s_nop 0
    buffer_load_dwordx4 v4, s[8:11], s32 offen sc1 lds
    s_add_u32 s32, s32, 55296
    s_add_u32 s33, s33, 1024
    s_mov_b32 m0, s33
    s_nop 0
    buffer_load_dwordx4 v4, s[8:11], s32 offen sc1 lds
    ds_read_b128 v[132:135], v237 offset:51200
    s_waitcnt lgkmcnt(10) vmcnt(27)
    v_mfma_f32_16x16x32_bf16 v[192:195], v[136:139], v[60:63], v[192:195]
    ds_read_b128 v[136:139], v237 offset:52224
    s_waitcnt lgkmcnt(10)
    v_mfma_f32_16x16x32_bf16 v[196:199], v[140:143], v[60:63], v[196:199]
    ds_read_b128 v[140:143], v237 offset:53248
    s_waitcnt lgkmcnt(10)
    v_mfma_f32_16x16x32_bf16 v[200:203], v[144:147], v[60:63], v[200:203]
    ds_read_b128 v[144:147], v237 offset:54272
    s_waitcnt lgkmcnt(10)
    v_mfma_f32_16x16x32_bf16 v[204:207], v[148:151], v[60:63], v[204:207]
    ds_read_b128 v[148:151], v237 offset:55296
    s_waitcnt lgkmcnt(10)
    v_mfma_f32_16x16x32_bf16 v[208:211], v[152:155], v[60:63], v[208:211]
    ds_read_b128 v[152:155], v238 offset:0
    s_waitcnt lgkmcnt(10) vmcnt(26)
    v_mfma_f32_16x16x32_bf16 v[192:195], v[156:159], v[64:67], v[192:195]
    ds_read_b128 v[156:159], v238 offset:1024
    s_waitcnt lgkmcnt(10)
    v_mfma_f32_16x16x32_bf16 v[196:199], v[160:163], v[64:67], v[196:199]
    ds_read_b128 v[160:163], v238 offset:2048
    s_waitcnt lgkmcnt(10)
    v_mfma_f32_16x16x32_bf16 v[200:203], v[164:167], v[64:67], v[200:203]
    ds_read_b128 v[164:167], v238 offset:3072
    s_waitcnt lgkmcnt(10)
    v_mfma_f32_16x16x32_bf16 v[204:207], v[168:171], v[64:67], v[204:207]
    ds_read_b128 v[168:171], v238 offset:4096
    s_waitcnt lgkmcnt(10)
    v_mfma_f32_16x16x32_bf16 v[208:211], v[172:175], v[64:67], v[208:211]
    ds_read_b128 v[172:175], v238 offset:10240
    s_waitcnt lgkmcnt(10) vmcnt(25)
    v_mfma_f32_16x16x32_bf16 v[192:195], v[132:135], v[68:71], v[192:195]
    ds_read_b128 v[132:135], v238 offset:11264
    s_waitcnt lgkmcnt(10)
    v_mfma_f32_16x16x32_bf16 v[196:199], v[136:139], v[68:71], v[196:199]
    ds_read_b128 v[136:139], v238 offset:12288
    s_waitcnt lgkmcnt(10)
    v_mfma_f32_16x16x32_bf16 v[200:203], v[140:143], v[68:71], v[200:203]
    ds_read_b128 v[140:143], v238 offset:13312
    s_waitcnt lgkmcnt(10)
    v_mfma_f32_16x16x32_bf16 v[204:207], v[144:147], v[68:71], v[204:207]
    ds_read_b128 v[144:147], v238 offset:14336
    s_waitcnt lgkmcnt(10)
    v_mfma_f32_16x16x32_bf16 v[208:211], v[148:151], v[68:71], v[208:211]
    ds_read_b128 v[148:151], v238 offset:20480
    s_waitcnt lgkmcnt(10) vmcnt(24)
    v_mfma_f32_16x16x32_bf16 v[192:195], v[152:155], v[72:75], v[192:195]
    ds_read_b128 v[152:155], v238 offset:21504
    s_waitcnt lgkmcnt(10)
    v_mfma_f32_16x16x32_bf16 v[196:199], v[156:159], v[72:75], v[196:199]
    ds_read_b128 v[156:159], v238 offset:22528
    s_waitcnt lgkmcnt(10)
    v_mfma_f32_16x16x32_bf16 v[200:203], v[160:163], v[72:75], v[200:203]
    ds_read_b128 v[160:163], v238 offset:23552
    s_waitcnt lgkmcnt(10)
    v_mfma_f32_16x16x32_bf16 v[204:207], v[164:167], v[72:75], v[204:207]
    ds_read_b128 v[164:167], v238 offset:24576
    s_waitcnt lgkmcnt(10)
    v_mfma_f32_16x16x32_bf16 v[208:211], v[168:171], v[72:75], v[208:211]
    s_waitcnt vmcnt(5)
    s_barrier
    s_lshr_b32 s28, s3, 1
    s_and_b32 s29, s3, 1
    s_add_u32 s30, s28, 23
    s_mul_i32 s32, s29, 27
    s_add_u32 s32, s32, s30
    s_mul_i32 s33, s7, 270
    s_add_u32 s32, s32, s33
    s_lshl_b32 s32, s32, 10
    s_add_u32 s32, s32, 30490624
    s_add_u32 s30, s28, 8
    s_mul_i32 s33, s30, 10240
    s_mul_i32 s29, s29, 5120
    s_add_u32 s33, s33, s29
    s_mov_b32 m0, s33
    s_nop 0
    buffer_load_dwordx4 v4, s[8:11], s32 offen sc1 lds
    s_add_u32 s32, s32, 55296
    s_add_u32 s33, s33, 1024
    s_mov_b32 m0, s33
    s_nop 0
    buffer_load_dwordx4 v4, s[8:11], s32 offen sc1 lds
    s_add_u32 s32, s32, 55296
    s_add_u32 s33, s33, 1024
    s_mov_b32 m0, s33
    s_nop 0
    buffer_load_dwordx4 v4, s[8:11], s32 offen sc1 lds
    s_add_u32 s32, s32, 55296
    s_add_u32 s33, s33, 1024
    s_mov_b32 m0, s33
    s_nop 0
    buffer_load_dwordx4 v4, s[8:11], s32 offen sc1 lds
    s_add_u32 s32, s32, 55296
    s_add_u32 s33, s33, 1024
    s_mov_b32 m0, s33
    s_nop 0
    buffer_load_dwordx4 v4, s[8:11], s32 offen sc1 lds
    ds_read_b128 v[168:171], v236 offset:0
    s_waitcnt lgkmcnt(10) vmcnt(28)
    v_mfma_f32_16x16x32_bf16 v[192:195], v[172:175], v[76:79], v[192:195]
    ds_read_b128 v[172:175], v236 offset:1024
    s_waitcnt lgkmcnt(10)
    v_mfma_f32_16x16x32_bf16 v[196:199], v[132:135], v[76:79], v[196:199]
    ds_read_b128 v[132:135], v236 offset:2048
    s_waitcnt lgkmcnt(10)
    v_mfma_f32_16x16x32_bf16 v[200:203], v[136:139], v[76:79], v[200:203]
    ds_read_b128 v[136:139], v236 offset:3072
    s_waitcnt lgkmcnt(10)
    v_mfma_f32_16x16x32_bf16 v[204:207], v[140:143], v[76:79], v[204:207]
    ds_read_b128 v[140:143], v236 offset:4096
    s_waitcnt lgkmcnt(10)
    v_mfma_f32_16x16x32_bf16 v[208:211], v[144:147], v[76:79], v[208:211]
    ds_read_b128 v[144:147], v236 offset:10240
    s_waitcnt lgkmcnt(10) vmcnt(27)
    v_mfma_f32_16x16x32_bf16 v[192:195], v[148:151], v[80:83], v[192:195]
    ds_read_b128 v[148:151], v236 offset:11264
    s_waitcnt lgkmcnt(10)
    v_mfma_f32_16x16x32_bf16 v[196:199], v[152:155], v[80:83], v[196:199]
    ds_read_b128 v[152:155], v236 offset:12288
    s_waitcnt lgkmcnt(10)
    v_mfma_f32_16x16x32_bf16 v[200:203], v[156:159], v[80:83], v[200:203]
    ds_read_b128 v[156:159], v236 offset:13312
    s_waitcnt lgkmcnt(10)
    v_mfma_f32_16x16x32_bf16 v[204:207], v[160:163], v[80:83], v[204:207]
    ds_read_b128 v[160:163], v236 offset:14336
    s_waitcnt lgkmcnt(10)
    v_mfma_f32_16x16x32_bf16 v[208:211], v[164:167], v[80:83], v[208:211]
    ds_read_b128 v[164:167], v236 offset:20480
    s_waitcnt lgkmcnt(10) vmcnt(26)
    v_mfma_f32_16x16x32_bf16 v[192:195], v[168:171], v[84:87], v[192:195]
    ds_read_b128 v[168:171], v236 offset:21504
    s_waitcnt lgkmcnt(10)
    v_mfma_f32_16x16x32_bf16 v[196:199], v[172:175], v[84:87], v[196:199]
    ds_read_b128 v[172:175], v236 offset:22528
    s_waitcnt lgkmcnt(10)
    v_mfma_f32_16x16x32_bf16 v[200:203], v[132:135], v[84:87], v[200:203]
    ds_read_b128 v[132:135], v236 offset:23552
    s_waitcnt lgkmcnt(10)
    v_mfma_f32_16x16x32_bf16 v[204:207], v[136:139], v[84:87], v[204:207]
    ds_read_b128 v[136:139], v236 offset:24576
    s_waitcnt lgkmcnt(10)
    v_mfma_f32_16x16x32_bf16 v[208:211], v[140:143], v[84:87], v[208:211]
    ds_read_b128 v[140:143], v236 offset:30720
    s_waitcnt lgkmcnt(10) vmcnt(25)
    v_mfma_f32_16x16x32_bf16 v[192:195], v[144:147], v[88:91], v[192:195]
    ds_read_b128 v[144:147], v236 offset:31744
    s_waitcnt lgkmcnt(10)
    v_mfma_f32_16x16x32_bf16 v[196:199], v[148:151], v[88:91], v[196:199]
    ds_read_b128 v[148:151], v236 offset:32768
    s_waitcnt lgkmcnt(10)
    v_mfma_f32_16x16x32_bf16 v[200:203], v[152:155], v[88:91], v[200:203]
    ds_read_b128 v[152:155], v236 offset:33792
    s_waitcnt lgkmcnt(10)
    v_mfma_f32_16x16x32_bf16 v[204:207], v[156:159], v[88:91], v[204:207]
    ds_read_b128 v[156:159], v236 offset:34816
    s_waitcnt lgkmcnt(10)
    v_mfma_f32_16x16x32_bf16 v[208:211], v[160:163], v[88:91], v[208:211]
    s_waitcnt vmcnt(5)
    s_barrier
    ds_read_b128 v[160:163], v236 offset:40960
    s_waitcnt lgkmcnt(10) vmcnt(24)
    v_mfma_f32_16x16x32_bf16 v[192:195], v[164:167], v[92:95], v[192:195]
    ds_read_b128 v[164:167], v236 offset:41984
    s_waitcnt lgkmcnt(10)
    v_mfma_f32_16x16x32_bf16 v[196:199], v[168:171], v[92:95], v[196:199]
    ds_read_b128 v[168:171], v236 offset:43008
    s_waitcnt lgkmcnt(10)
    v_mfma_f32_16x16x32_bf16 v[200:203], v[172:175], v[92:95], v[200:203]
    ds_read_b128 v[172:175], v236 offset:44032
    s_waitcnt lgkmcnt(10)
    v_mfma_f32_16x16x32_bf16 v[204:207], v[132:135], v[92:95], v[204:207]
    ds_read_b128 v[132:135], v236 offset:45056
    s_waitcnt lgkmcnt(10)
    v_mfma_f32_16x16x32_bf16 v[208:211], v[136:139], v[92:95], v[208:211]
    ds_read_b128 v[136:139], v236 offset:51200
    s_waitcnt lgkmcnt(10) vmcnt(23)
    v_mfma_f32_16x16x32_bf16 v[192:195], v[140:143], v[96:99], v[192:195]
    ds_read_b128 v[140:143], v236 offset:52224
    s_waitcnt lgkmcnt(10)
    v_mfma_f32_16x16x32_bf16 v[196:199], v[144:147], v[96:99], v[196:199]
    ds_read_b128 v[144:147], v236 offset:53248
    s_waitcnt lgkmcnt(10)
    v_mfma_f32_16x16x32_bf16 v[200:203], v[148:151], v[96:99], v[200:203]
    ds_read_b128 v[148:151], v236 offset:54272
    s_waitcnt lgkmcnt(10)
    v_mfma_f32_16x16x32_bf16 v[204:207], v[152:155], v[96:99], v[204:207]
    ds_read_b128 v[152:155], v236 offset:55296
    s_waitcnt lgkmcnt(10)
    v_mfma_f32_16x16x32_bf16 v[208:211], v[156:159], v[96:99], v[208:211]
    ds_read_b128 v[156:159], v237 offset:0
    s_waitcnt lgkmcnt(10) vmcnt(22)
    v_mfma_f32_16x16x32_bf16 v[192:195], v[160:163], v[100:103], v[192:195]
    ds_read_b128 v[160:163], v237 offset:1024
    s_waitcnt lgkmcnt(10)
    v_mfma_f32_16x16x32_bf16 v[196:199], v[164:167], v[100:103], v[196:199]
    ds_read_b128 v[164:167], v237 offset:2048
    s_waitcnt lgkmcnt(10)
    v_mfma_f32_16x16x32_bf16 v[200:203], v[168:171], v[100:103], v[200:203]
    ds_read_b128 v[168:171], v237 offset:3072
    s_waitcnt lgkmcnt(10)
    v_mfma_f32_16x16x32_bf16 v[204:207], v[172:175], v[100:103], v[204:207]
    ds_read_b128 v[172:175], v237 offset:4096
    s_waitcnt lgkmcnt(10)
    v_mfma_f32_16x16x32_bf16 v[208:211], v[132:135], v[100:103], v[208:211]
    ds_read_b128 v[132:135], v237 offset:10240
    s_waitcnt lgkmcnt(10) vmcnt(21)
    v_mfma_f32_16x16x32_bf16 v[192:195], v[136:139], v[104:107], v[192:195]
    ds_read_b128 v[136:139], v237 offset:11264
    s_waitcnt lgkmcnt(10)
    v_mfma_f32_16x16x32_bf16 v[196:199], v[140:143], v[104:107], v[196:199]
    ds_read_b128 v[140:143], v237 offset:12288
    s_waitcnt lgkmcnt(10)
    v_mfma_f32_16x16x32_bf16 v[200:203], v[144:147], v[104:107], v[200:203]
    ds_read_b128 v[144:147], v237 offset:13312
    s_waitcnt lgkmcnt(10)
    v_mfma_f32_16x16x32_bf16 v[204:207], v[148:151], v[104:107], v[204:207]
    ds_read_b128 v[148:151], v237 offset:14336
    s_waitcnt lgkmcnt(10)
    v_mfma_f32_16x16x32_bf16 v[208:211], v[152:155], v[104:107], v[208:211]
    s_waitcnt vmcnt(0)
    s_barrier
    ds_read_b128 v[152:155], v237 offset:20480
    s_waitcnt lgkmcnt(10) vmcnt(20)
    v_mfma_f32_16x16x32_bf16 v[192:195], v[156:159], v[108:111], v[192:195]
    ds_read_b128 v[156:159], v237 offset:21504
    s_waitcnt lgkmcnt(10)
    v_mfma_f32_16x16x32_bf16 v[196:199], v[160:163], v[108:111], v[196:199]
    ds_read_b128 v[160:163], v237 offset:22528
    s_waitcnt lgkmcnt(10)
    v_mfma_f32_16x16x32_bf16 v[200:203], v[164:167], v[108:111], v[200:203]
    ds_read_b128 v[164:167], v237 offset:23552
    s_waitcnt lgkmcnt(10)
    v_mfma_f32_16x16x32_bf16 v[204:207], v[168:171], v[108:111], v[204:207]
    ds_read_b128 v[168:171], v237 offset:24576
    s_waitcnt lgkmcnt(10)
    v_mfma_f32_16x16x32_bf16 v[208:211], v[172:175], v[108:111], v[208:211]
    ds_read_b128 v[172:175], v237 offset:30720
    s_waitcnt lgkmcnt(10) vmcnt(19)
    v_mfma_f32_16x16x32_bf16 v[192:195], v[132:135], v[112:115], v[192:195]
    ds_read_b128 v[132:135], v237 offset:31744
    s_waitcnt lgkmcnt(10)
    v_mfma_f32_16x16x32_bf16 v[196:199], v[136:139], v[112:115], v[196:199]
    ds_read_b128 v[136:139], v237 offset:32768
    s_waitcnt lgkmcnt(10)
    v_mfma_f32_16x16x32_bf16 v[200:203], v[140:143], v[112:115], v[200:203]
    ds_read_b128 v[140:143], v237 offset:33792
    s_waitcnt lgkmcnt(10)
    v_mfma_f32_16x16x32_bf16 v[204:207], v[144:147], v[112:115], v[204:207]
    ds_read_b128 v[144:147], v237 offset:34816
    s_waitcnt lgkmcnt(10)
    v_mfma_f32_16x16x32_bf16 v[208:211], v[148:151], v[112:115], v[208:211]
    ds_read_b128 v[148:151], v237 offset:40960
    s_waitcnt lgkmcnt(10) vmcnt(18)
    v_mfma_f32_16x16x32_bf16 v[192:195], v[152:155], v[116:119], v[192:195]
    ds_read_b128 v[152:155], v237 offset:41984
    s_waitcnt lgkmcnt(10)
    v_mfma_f32_16x16x32_bf16 v[196:199], v[156:159], v[116:119], v[196:199]
    ds_read_b128 v[156:159], v237 offset:43008
    s_waitcnt lgkmcnt(10)
    v_mfma_f32_16x16x32_bf16 v[200:203], v[160:163], v[116:119], v[200:203]
    ds_read_b128 v[160:163], v237 offset:44032
    s_waitcnt lgkmcnt(10)
    v_mfma_f32_16x16x32_bf16 v[204:207], v[164:167], v[116:119], v[204:207]
    ds_read_b128 v[164:167], v237 offset:45056
    s_waitcnt lgkmcnt(10)
    v_mfma_f32_16x16x32_bf16 v[208:211], v[168:171], v[116:119], v[208:211]
    ds_read_b128 v[168:171], v237 offset:51200
    s_waitcnt lgkmcnt(10) vmcnt(17)
    v_mfma_f32_16x16x32_bf16 v[192:195], v[172:175], v[120:123], v[192:195]
    ds_read_b128 v[172:175], v237 offset:52224
    s_waitcnt lgkmcnt(10)
    v_mfma_f32_16x16x32_bf16 v[196:199], v[132:135], v[120:123], v[196:199]
    ds_read_b128 v[132:135], v237 offset:53248
    s_waitcnt lgkmcnt(10)
    v_mfma_f32_16x16x32_bf16 v[200:203], v[136:139], v[120:123], v[200:203]
    ds_read_b128 v[136:139], v237 offset:54272
    s_waitcnt lgkmcnt(10)
    v_mfma_f32_16x16x32_bf16 v[204:207], v[140:143], v[120:123], v[204:207]
    ds_read_b128 v[140:143], v237 offset:55296
    s_waitcnt lgkmcnt(10)
    v_mfma_f32_16x16x32_bf16 v[208:211], v[144:147], v[120:123], v[208:211]
    s_waitcnt lgkmcnt(9) vmcnt(16)
    v_mfma_f32_16x16x32_bf16 v[192:195], v[148:151], v[124:127], v[192:195]
    s_waitcnt lgkmcnt(8)
    v_mfma_f32_16x16x32_bf16 v[196:199], v[152:155], v[124:127], v[196:199]
    s_waitcnt lgkmcnt(7)
    v_mfma_f32_16x16x32_bf16 v[200:203], v[156:159], v[124:127], v[200:203]
    s_waitcnt lgkmcnt(6)
    v_mfma_f32_16x16x32_bf16 v[204:207], v[160:163], v[124:127], v[204:207]
    s_waitcnt lgkmcnt(5)
    v_mfma_f32_16x16x32_bf16 v[208:211], v[164:167], v[124:127], v[208:211]
    s_waitcnt lgkmcnt(4) vmcnt(15)
    v_mfma_f32_16x16x32_bf16 v[192:195], v[168:171], v[128:131], v[192:195]
    s_waitcnt lgkmcnt(3)
    v_mfma_f32_16x16x32_bf16 v[196:199], v[172:175], v[128:131], v[196:199]
    s_waitcnt lgkmcnt(2)
    v_mfma_f32_16x16x32_bf16 v[200:203], v[132:135], v[128:131], v[200:203]
    s_waitcnt lgkmcnt(1)
    v_mfma_f32_16x16x32_bf16 v[204:207], v[136:139], v[128:131], v[204:207]
    s_waitcnt lgkmcnt(0)
    v_mfma_f32_16x16x32_bf16 v[208:211], v[140:143], v[128:131], v[208:211]
    s_barrier
    s_mul_i32 s28, s4, 5120
    s_add_u32 s28, s28, 128000
    v_add_u32 v57, s28, v4
    s_cmp_eq_u32 s5, 1
    s_cbranch_scc1 interleave_layers__grouped_kv_mqa__mixer_channel_mlp__prompt_kernel_r194
    ds_write_b128 v57, v[204:207] offset:3072
    s_nop 0
    ds_write_b128 v57, v[208:211] offset:4096
    s_branch interleave_layers__grouped_kv_mqa__mixer_channel_mlp__prompt_kernel_r295
interleave_layers__grouped_kv_mqa__mixer_channel_mlp__prompt_kernel_r194:
    ds_write_b128 v57, v[192:195] offset:0
    ds_write_b128 v57, v[196:199] offset:1024
    ds_write_b128 v57, v[200:203] offset:2048
    v_mov_b32 v192, v204
    v_mov_b32 v193, v205
    v_mov_b32 v194, v206
    v_mov_b32 v195, v207
    v_mov_b32 v196, v208
    v_mov_b32 v197, v209
    v_mov_b32 v198, v210
    v_mov_b32 v199, v211
interleave_layers__grouped_kv_mqa__mixer_channel_mlp__prompt_kernel_r295:
    s_waitcnt lgkmcnt(0)
    s_barrier
    s_mul_i32 s29, s5, 3072
    v_add_u32 v57, s29, v57
    ds_read_b128 v[24:27], v57 offset:0
    ds_read_b128 v[28:31], v57 offset:1024
    ds_read_b128 v[32:35], v57 offset:2048
    s_waitcnt lgkmcnt(0)
    v_add_f32 v192, v192, v24
    v_add_f32 v193, v193, v25
    v_add_f32 v194, v194, v26
    v_add_f32 v195, v195, v27
    v_add_f32 v196, v196, v28
    v_add_f32 v197, v197, v29
    v_add_f32 v198, v198, v30
    v_add_f32 v199, v199, v31
    v_add_f32 v200, v200, v32
    v_add_f32 v201, v201, v33
    v_add_f32 v202, v202, v34
    v_add_f32 v203, v203, v35
    s_lshl_b32 s28, s6, 2
    s_add_u32 s28, s28, s4
    s_mul_i32 s28, s28, 20480
    s_mul_i32 s29, s7, 5
    s_mul_i32 s30, s5, 3
    s_add_u32 s29, s29, s30
    s_add_u32 s30, s29, 0
    s_lshl_b32 s30, s30, 9
    s_add_u32 s44, s30, s28
    s_add_u32 s30, s29, 1
    s_lshl_b32 s30, s30, 9
    s_add_u32 s45, s30, s28
    s_add_u32 s30, s29, 2
    s_lshl_b32 s30, s30, 9
    s_add_u32 s46, s30, s28
    s_mov_b32 s28, 25657344
    s_add_u32 s44, s44, s28
    s_add_u32 s45, s45, s28
    s_add_u32 s46, s46, s28
    s_mov_b32 s47, 0xffff0000
    v_lshrrev_b32 v63, 1, v3
    v_lshlrev_b32 v63, 8, v63
    v_lshl_add_u32 v63, v2, 4, v63
    v_and_b32 v62, 1, v3
    v_lshl_add_u32 v63, v62, 3, v63
    v_lshlrev_b32 v48, 16, v8
    v_and_b32 v49, s47, v8
    v_lshlrev_b32 v50, 16, v9
    v_and_b32 v51, s47, v9
    v_add_f32 v192, v192, v48
    v_add_f32 v193, v193, v49
    v_add_f32 v194, v194, v50
    v_add_f32 v195, v195, v51
    v_lshlrev_b32 v48, 16, v240
    v_and_b32 v49, s47, v240
    v_lshlrev_b32 v50, 16, v241
    v_and_b32 v51, s47, v241
    v_add_f32 v192, v192, v48
    v_add_f32 v193, v193, v49
    v_add_f32 v194, v194, v50
    v_add_f32 v195, v195, v51
    v_cvt_pk_bf16_f32 v8, v192, v193
    v_cvt_pk_bf16_f32 v9, v194, v195
    s_cmp_eq_u32 s12, 1
    s_cbranch_scc1 interleave_layers__grouped_kv_mqa__mixer_channel_mlp__prompt_kernel_fin97
    buffer_store_dwordx2 v[8:9], v63, s[8:11], s44 offen sc1
    s_branch interleave_layers__grouped_kv_mqa__mixer_channel_mlp__prompt_kernel_fd98
interleave_layers__grouped_kv_mqa__mixer_channel_mlp__prompt_kernel_fin97:
    buffer_store_dwordx2 v[8:9], v246, s[24:27], 0 offen offset:0
interleave_layers__grouped_kv_mqa__mixer_channel_mlp__prompt_kernel_fd98:
    v_lshlrev_b32 v48, 16, v10
    v_and_b32 v49, s47, v10
    v_lshlrev_b32 v50, 16, v11
    v_and_b32 v51, s47, v11
    v_add_f32 v196, v196, v48
    v_add_f32 v197, v197, v49
    v_add_f32 v198, v198, v50
    v_add_f32 v199, v199, v51
    v_lshlrev_b32 v48, 16, v242
    v_and_b32 v49, s47, v242
    v_lshlrev_b32 v50, 16, v243
    v_and_b32 v51, s47, v243
    v_add_f32 v196, v196, v48
    v_add_f32 v197, v197, v49
    v_add_f32 v198, v198, v50
    v_add_f32 v199, v199, v51
    v_cvt_pk_bf16_f32 v10, v196, v197
    v_cvt_pk_bf16_f32 v11, v198, v199
    s_cmp_eq_u32 s12, 1
    s_cbranch_scc1 interleave_layers__grouped_kv_mqa__mixer_channel_mlp__prompt_kernel_fin99
    buffer_store_dwordx2 v[10:11], v63, s[8:11], s45 offen sc1
    s_branch interleave_layers__grouped_kv_mqa__mixer_channel_mlp__prompt_kernel_fd100
interleave_layers__grouped_kv_mqa__mixer_channel_mlp__prompt_kernel_fin99:
    buffer_store_dwordx2 v[10:11], v246, s[24:27], 0 offen offset:32
interleave_layers__grouped_kv_mqa__mixer_channel_mlp__prompt_kernel_fd100:
    s_cmp_eq_u32 s5, 1
    s_cbranch_scc1 interleave_layers__grouped_kv_mqa__mixer_channel_mlp__prompt_kernel_e396
    v_lshlrev_b32 v48, 16, v12
    v_and_b32 v49, s47, v12
    v_lshlrev_b32 v50, 16, v13
    v_and_b32 v51, s47, v13
    v_add_f32 v200, v200, v48
    v_add_f32 v201, v201, v49
    v_add_f32 v202, v202, v50
    v_add_f32 v203, v203, v51
    v_lshlrev_b32 v48, 16, v244
    v_and_b32 v49, s47, v244
    v_lshlrev_b32 v50, 16, v245
    v_and_b32 v51, s47, v245
    v_add_f32 v200, v200, v48
    v_add_f32 v201, v201, v49
    v_add_f32 v202, v202, v50
    v_add_f32 v203, v203, v51
    v_cvt_pk_bf16_f32 v12, v200, v201
    v_cvt_pk_bf16_f32 v13, v202, v203
    s_cmp_eq_u32 s12, 1
    s_cbranch_scc1 interleave_layers__grouped_kv_mqa__mixer_channel_mlp__prompt_kernel_fin101
    buffer_store_dwordx2 v[12:13], v63, s[8:11], s46 offen sc1
    s_branch interleave_layers__grouped_kv_mqa__mixer_channel_mlp__prompt_kernel_fd102
interleave_layers__grouped_kv_mqa__mixer_channel_mlp__prompt_kernel_fin101:
    buffer_store_dwordx2 v[12:13], v246, s[24:27], 0 offen offset:64
interleave_layers__grouped_kv_mqa__mixer_channel_mlp__prompt_kernel_fd102:
interleave_layers__grouped_kv_mqa__mixer_channel_mlp__prompt_kernel_e396:
    s_cmp_eq_u32 s12, 1
    s_cbranch_scc1 mega_kernel_end
    s_waitcnt vmcnt(0)
    s_barrier
    s_cmp_lg_u32 s3, 0
    s_cbranch_scc1 interleave_layers__grouped_kv_mqa__mixer_channel_mlp__prompt_kernel_pub103
    s_add_u32 s28, s13, 5
    v_mov_b32 v22, s28
    s_lshl_b32 s29, s6, 8
    s_lshl_b32 s30, s7, 2
    s_add_u32 s29, s29, s30
    v_mov_b32 v21, s29
    s_mov_b64 exec, 1
    buffer_store_dword v22, v21, s[8:11], 0 offen offset:0 sc1
    s_mov_b64 exec, -1
interleave_layers__grouped_kv_mqa__mixer_channel_mlp__prompt_kernel_pub103:
    s_cmp_eq_u32 s3, 7
    s_cbranch_scc1 interleave_layers__grouped_kv_mqa__mixer_channel_mlp__prompt_kernel_dn104
    s_and_b32 s28, s7, 1
    s_cmp_eq_u32 s28, 0
    s_cselect_b32 s30, s68, s70
    s_cselect_b32 s31, s69, s71
    s_mov_b32 s20, s30
    s_mov_b32 s21, s31
    s_and_b32 s21, s21, 0xffff
    s_mov_b32 s22, 25600
    s_mov_b32 s23, 0x20000
    s_add_u32 s28, s3, 0
    s_lshl_b32 s29, s28, 10
    s_add_u32 s30, s29, 102400
    s_mov_b32 m0, s30
    s_nop 0
    buffer_load_dwordx4 v4, s[20:23], s29 offen lds
interleave_layers__grouped_kv_mqa__mixer_channel_mlp__prompt_kernel_wk105:
    s_add_u32 s28, s3, 7
    s_lshl_b32 s29, s28, 10
    s_add_u32 s30, s29, 102400
    s_mov_b32 m0, s30
    s_nop 0
    buffer_load_dwordx4 v4, s[20:23], s29 offen lds
interleave_layers__grouped_kv_mqa__mixer_channel_mlp__prompt_kernel_wk106:
    s_add_u32 s28, s3, 14
    s_lshl_b32 s29, s28, 10
    s_add_u32 s30, s29, 102400
    s_mov_b32 m0, s30
    s_nop 0
    buffer_load_dwordx4 v4, s[20:23], s29 offen lds
interleave_layers__grouped_kv_mqa__mixer_channel_mlp__prompt_kernel_wk107:
    s_add_u32 s28, s3, 21
    s_cmp_ge_u32 s28, 25
    s_cbranch_scc1 interleave_layers__grouped_kv_mqa__mixer_channel_mlp__prompt_kernel_wk108
    s_lshl_b32 s29, s28, 10
    s_add_u32 s30, s29, 102400
    s_mov_b32 m0, s30
    s_nop 0
    buffer_load_dwordx4 v4, s[20:23], s29 offen lds
interleave_layers__grouped_kv_mqa__mixer_channel_mlp__prompt_kernel_wk108:
    s_mul_i32 s28, s7, 102400
    s_add_u32 s28, s28, 33521664
    s_lshl_b32 s29, s3, 10
    s_add_u32 s28, s28, s29
    s_mov_b32 m0, s29
    s_nop 0
    buffer_load_dwordx4 v4, s[8:11], s28 offen sc1 lds
    s_add_u32 s28, s28, 7168
    s_add_u32 s29, s29, 7168
    s_mov_b32 m0, s29
    s_nop 0
    buffer_load_dwordx4 v4, s[8:11], s28 offen sc1 lds
    s_add_u32 s28, s28, 7168
    s_add_u32 s29, s29, 7168
    s_mov_b32 m0, s29
    s_nop 0
    buffer_load_dwordx4 v4, s[8:11], s28 offen sc1 lds
    s_add_u32 s28, s28, 7168
    s_add_u32 s29, s29, 7168
    s_mov_b32 m0, s29
    s_nop 0
    buffer_load_dwordx4 v4, s[8:11], s28 offen sc1 lds
    s_add_u32 s28, s28, 7168
    s_add_u32 s29, s29, 7168
    s_mov_b32 m0, s29
    s_nop 0
    buffer_load_dwordx4 v4, s[8:11], s28 offen sc1 lds
    s_add_u32 s28, s28, 7168
    s_add_u32 s29, s29, 7168
    s_mov_b32 m0, s29
    s_nop 0
    buffer_load_dwordx4 v4, s[8:11], s28 offen sc1 lds
    s_add_u32 s28, s28, 7168
    s_add_u32 s29, s29, 7168
    s_mov_b32 m0, s29
    s_nop 0
    buffer_load_dwordx4 v4, s[8:11], s28 offen sc1 lds
    s_add_u32 s28, s28, 7168
    s_add_u32 s29, s29, 7168
    s_mov_b32 m0, s29
    s_nop 0
    buffer_load_dwordx4 v4, s[8:11], s28 offen sc1 lds
    s_add_u32 s28, s28, 7168
    s_add_u32 s29, s29, 7168
    s_mov_b32 m0, s29
    s_nop 0
    buffer_load_dwordx4 v4, s[8:11], s28 offen sc1 lds
    s_add_u32 s28, s28, 7168
    s_add_u32 s29, s29, 7168
    s_mov_b32 m0, s29
    s_nop 0
    buffer_load_dwordx4 v4, s[8:11], s28 offen sc1 lds
    s_add_u32 s28, s28, 7168
    s_add_u32 s29, s29, 7168
    s_mov_b32 m0, s29
    s_nop 0
    buffer_load_dwordx4 v4, s[8:11], s28 offen sc1 lds
    s_add_u32 s28, s28, 7168
    s_add_u32 s29, s29, 7168
    s_mov_b32 m0, s29
    s_nop 0
    buffer_load_dwordx4 v4, s[8:11], s28 offen sc1 lds
    s_add_u32 s28, s28, 7168
    s_add_u32 s29, s29, 7168
    s_mov_b32 m0, s29
    s_nop 0
    buffer_load_dwordx4 v4, s[8:11], s28 offen sc1 lds
    s_add_u32 s28, s28, 7168
    s_add_u32 s29, s29, 7168
    s_mov_b32 m0, s29
    s_nop 0
    buffer_load_dwordx4 v4, s[8:11], s28 offen sc1 lds
    s_add_u32 s28, s28, 7168
    s_add_u32 s29, s29, 7168
    s_cmp_ge_u32 s3, 2
    s_cbranch_scc1 interleave_layers__grouped_kv_mqa__mixer_channel_mlp__prompt_kernel_dl109
    s_mov_b32 m0, s29
    s_nop 0
    buffer_load_dwordx4 v4, s[8:11], s28 offen sc1 lds
interleave_layers__grouped_kv_mqa__mixer_channel_mlp__prompt_kernel_dl109:
interleave_layers__grouped_kv_mqa__mixer_channel_mlp__prompt_kernel_dn104:
    s_cmp_lg_u32 s3, 7
    s_cbranch_scc1 interleave_layers__grouped_kv_mqa__mixer_channel_mlp__prompt_kernel_w110
    s_add_u32 s28, s13, 5
    v_and_b32 v21, 7, v1
    v_lshlrev_b32 v21, 2, v21
    s_lshl_b32 s29, s6, 8
    v_add_u32 v21, s29, v21
    v_mov_b32 v22, s28
    s_mov_b32 s30, 0
interleave_layers__grouped_kv_mqa__mixer_channel_mlp__prompt_kernel_poll111:
    buffer_load_dword v16, v21, s[8:11], 0 offen offset:0 sc1
    s_waitcnt vmcnt(0)
    v_sub_u32 v16, v16, v22
    v_cmp_le_u32 vcc, 32, v16
    s_cbranch_vccz interleave_layers__grouped_kv_mqa__mixer_channel_mlp__prompt_kernel_pd112
    s_sleep 1
    s_add_u32 s30, s30, 1
    s_cmp_lt_u32 s30, 0x40000
    s_cbranch_scc1 interleave_layers__grouped_kv_mqa__mixer_channel_mlp__prompt_kernel_poll111
interleave_layers__grouped_kv_mqa__mixer_channel_mlp__prompt_kernel_pd112:
interleave_layers__grouped_kv_mqa__mixer_channel_mlp__prompt_kernel_w110:
    s_barrier
    s_mov_b32 s12, 1
    s_add_u32 s13, s13, 5
    s_branch mega_layer
mega_kernel_end:
    s_cmp_lg_u32 s2, 0
    s_cbranch_scc1 interleave_layers__grouped_kv_mqa__mixer_channel_mlp__prompt_kernel_rz113
    s_cmp_lg_u32 s3, 5
    s_cbranch_scc1 interleave_layers__grouped_kv_mqa__mixer_channel_mlp__prompt_kernel_rz113
    s_load_dwordx2 s[58:59], s[0:1], 88
    s_waitcnt lgkmcnt(0)
    s_mov_b32 s60, s58
    s_mov_b32 s61, s59
    s_and_b32 s61, s61, 0xffff
    s_mov_b32 s62, 256
    s_mov_b32 s63, 0x20000
    v_mov_b32 v200, 0
    v_mov_b32 v201, 0
    s_mov_b64 exec, 1
    buffer_store_dword v201, v200, s[60:63], 0 offen sc1
    s_mov_b64 exec, -1
interleave_layers__grouped_kv_mqa__mixer_channel_mlp__prompt_kernel_rz113:
mega_kernel_exit:
mega_code_end:
    s_endpgm
.section .rodata,"a"
.p2align 6
.amdhsa_kernel interleave_layers__grouped_kv_mqa__mixer_channel_mlp__prompt_kernel
  .amdhsa_next_free_vgpr 256
  .amdhsa_next_free_sgpr 102
  .amdhsa_accum_offset 256
  .amdhsa_group_segment_fixed_size 0
  .amdhsa_kernarg_size 104
  .amdhsa_user_sgpr_count 2
  .amdhsa_user_sgpr_kernarg_segment_ptr 1
  .amdhsa_system_sgpr_workgroup_id_x 1
.end_amdhsa_kernel
```
